```python
import torch

def _softmax(x, axis=-1):
    return torch.softmax(x, dim=axis)
def _gelu(x):
    return torch.nn.functional.gelu(x, approximate="tanh")
def _silu(x):
    return torch.nn.functional.silu(x)
def _sigmoid(x):
    return torch.sigmoid(x)
def _layernorm(x, axis=-1, eps=1e-5):
    m = x.mean(dim=axis, keepdim=True)
    v = x.var(dim=axis, keepdim=True, unbiased=False)
    return (x - m) / torch.sqrt(v + eps)
def _scatter_add(tgt, idx, src, axis=0):
    return tgt.clone().index_add_(axis, idx, src)
def _segment_sum(src, seg, n):
    out = torch.zeros((n,) + src.shape[1:], dtype=src.dtype)
    return out.index_add_(0, seg, src)
def _pad(x, pw):
    flat = tuple(v for pair in reversed(pw) for v in pair)
    return torch.nn.functional.pad(x, flat)

kernel_name = 'recurrent_scan__mha_block_cached__swiglu_ffn__decode'

def setup_inputs():

    _w = (lambda a: (lambda t: t.to(torch.bfloat16) if t.is_floating_point() else t)(torch.as_tensor(a)))
    def _A_setup():
        B, Sq, D = 2, 1, 576
        H, Sk, Dh = 32, 8192, 128
        return {
            "x": _w((lambda *s: torch.randn(*s, dtype=torch.bfloat16) * 0.05)(B, Sq, D)),
            "k_cache": _w((lambda *s: torch.randn(*s, dtype=torch.bfloat16) * 1.6)(B, H, Sk, Dh)),
            "v_cache": _w((lambda *s: torch.randn(*s, dtype=torch.bfloat16) * 0.2)(B, H, Sk, Dh)),
            "wq": _w((lambda *s: torch.randn(*s, dtype=torch.bfloat16) * 1.6)(D, H * Dh) * (D ** -0.5)),
            "wo": _w((lambda *s: torch.randn(*s, dtype=torch.bfloat16) * 0.2)(H * Dh, D) * ((H * Dh) ** -0.5)),
        }
    _A_in = _A_setup()

    def _B_setup():
        B, S, D, F = 2, 1, 576, 4608
        return {
            "x": _w((lambda *s: torch.randn(*s, dtype=torch.bfloat16) * 0.05)(B, S, D)),
            "w_gate": _w((lambda *s: torch.randn(*s, dtype=torch.bfloat16) * 0.1)(D, F)),
            "w_up": _w((lambda *s: torch.randn(*s, dtype=torch.bfloat16) * 0.1)(D, F)),
            "w_down": _w((lambda *s: torch.randn(*s, dtype=torch.bfloat16) * 0.1)(F, D)),
        }
    _B_in = _B_setup()

    return {
        "A_x": _A_in["x"],
        "A_k_cache": _A_in["k_cache"],
        "A_v_cache": _A_in["v_cache"],
        "A_wq": _A_in["wq"],
        "A_wo": _A_in["wo"],
        "B_x": _B_in["x"],
        "B_w_gate": _B_in["w_gate"],
        "B_w_up": _B_in["w_up"],
        "B_w_down": _B_in["w_down"],
    }

def reference(A_x, A_k_cache, A_v_cache, A_wq, A_wo, B_x, B_w_gate, B_w_up, B_w_down):
    def _A_ref(x, k_cache, v_cache, wq, wo):
        B, Sq, D = x.shape
        H, Dh = 32, 128
        q = (lambda x, *d: x.permute(*d))((x @ wq).reshape(B, Sq, H, Dh), 0, 2, 1, 3)
        scores = torch.einsum("bhqd,bhkd->bhqk", q, k_cache) * (Dh ** -0.5)
        p = _softmax(scores, axis=-1)
        o = torch.einsum("bhqk,bhkd->bhqd", p, v_cache)
        return (lambda x, *d: x.permute(*d))(o, 0, 2, 1, 3).reshape(B, Sq, H * Dh) @ wo

    def _B_ref(x, w_gate, w_up, w_down):
        g = _silu(x @ w_gate)
        u = x @ w_up
        return (g * u) @ w_down

    x = A_x
    xn = _layernorm(x, axis=-1)
    s = _A_ref(xn, A_k_cache, A_v_cache, A_wq, A_wo)
    g = _silu(_B_ref(xn, B_w_gate, B_w_up, B_w_down))
    return x + s * g
```

```asm
; @launch grid=(256,1,1) block=(512,1,1) lds=18560
.amdgcn_target "amdgcn-amd-amdhsa--gfx950"
.text
.globl recurrent_scan__mha_block_cached__swiglu_ffn__decode_kernel
.p2align 8
.type recurrent_scan__mha_block_cached__swiglu_ffn__decode_kernel,@function
recurrent_scan__mha_block_cached__swiglu_ffn__decode_kernel:
    s_load_dwordx2 s[28:29], s[0:1], 8
    s_load_dwordx2 s[32:33], s[0:1], 16
    s_load_dwordx16 s[4:19], s[0:1], 0
    s_load_dwordx8 s[20:27], s[0:1], 64
    s_cmp_ge_u32 s2, 256
    s_cbranch_scc1 L_end
    v_lshrrev_b32 v1, 6, v0
    v_and_b32 v0, 63, v0
    v_readfirstlane_b32 s3, v1
    s_and_b32 s60, s2, 7
    s_lshr_b32 s59, s2, 3
    s_lshr_b32 s58, s60, 1
    s_mov_b32 s56, s59
    s_xor_b32 s57, s58, s60
    s_and_b32 s57, s57, 1
    s_add_u32 s58, s58, s59
    s_and_b32 s58, s58, 3
    s_mov_b32 s79, 0
    s_cmp_ge_u32 s3, 4
    s_cbranch_scc1 L_auxhead
    v_bfe_u32 v1, v0, 2, 2
    v_and_b32 v3, 2, v0
    v_lshl_add_u32 v1, v3, 1, v1
    v_lshlrev_b32 v1, 8, v1
    v_and_b32 v3, 1, v0
    v_lshl_add_u32 v1, v3, 6, v1
    v_lshrrev_b32 v3, 4, v0
    v_lshl_add_u32 v1, v3, 4, v1
    v_lshlrev_b32 v2, 4, v0
    s_lshl_b32 s80, s57, 26
    s_lshl_b32 s62, s56, 21
    s_add_u32 s80, s80, s62
    s_lshl_b32 s62, s3, 12
    s_add_u32 s80, s80, s62
    s_lshl_b32 s62, s58, 19
    s_add_u32 s61, s80, s62
    s_mov_b32 s30, 0x8000000
    s_mov_b32 s31, 0x20000
    s_mov_b32 s34, 0x8000000
    s_mov_b32 s35, 0x20000
    s_mov_b32 s82, 0
    s_cmp_eq_u32 s58, 0
    s_waitcnt lgkmcnt(0)
    s_cbranch_scc1 L_xe
    buffer_load_dwordx4 v[64:67], v1, s[28:31], s61 offen offset:0 nt
    buffer_load_dwordx4 v[68:71], v1, s[28:31], s61 offen offset:128 nt
    buffer_load_dwordx4 v[72:75], v1, s[28:31], s61 offen offset:2048 nt
    buffer_load_dwordx4 v[76:79], v1, s[28:31], s61 offen offset:2176 nt
    buffer_load_dwordx4 v[80:83], v2, s[32:35], s61 offen offset:0 nt
    buffer_load_dwordx4 v[84:87], v2, s[32:35], s61 offen offset:1024 nt
    buffer_load_dwordx4 v[88:91], v2, s[32:35], s61 offen offset:2048 nt
    buffer_load_dwordx4 v[92:95], v2, s[32:35], s61 offen offset:3072 nt
    s_mov_b32 s82, 1
    s_branch L_attn
L_xe:
    s_cmp_gt_u32 s3, 1
    s_cbranch_scc1 L_attn
    s_mov_b32 s36, s4
    s_mov_b32 s37, s5
    s_mov_b32 s38, 2304
    s_mov_b32 s39, 0x20000
    s_mul_i32 s64, s3, 1152
    v_lshlrev_b32 v9, 4, v0
    v_lshlrev_b32 v10, 1, v0
    v_mov_b32 v100, 0
    buffer_load_dwordx4 v[96:99], v9, s[36:39], s64 offen
    buffer_load_short_d16_hi v100, v10, s[36:39], s64 offen offset:1024
    s_branch L_attn
L_auxhead:
    s_sub_u32 s3, s3, 4
    v_and_b32 v1, 15, v0
    v_lshrrev_b32 v2, 4, v0
    v_lshlrev_b32 v3, 4, v1
    s_cmp_lg_u32 s58, 0
    s_cbranch_scc1 L_aux
    v_and_b32 v88, 7, v0
    v_lshlrev_b32 v88, 4, v88
    v_lshrrev_b32 v5, 3, v1
    v_lshl_add_u32 v5, v2, 1, v5
    v_lshl_add_u32 v86, v5, 14, v88
    v_lshl_add_u32 v88, v5, 15, v88
    v_add_u32 v89, 8192, v88
    v_add_u32 v90, 16384, v88
    v_add_u32 v91, 24576, v88
    v_add_u32 v87, 8192, v86
    s_mul_i32 s61, s3, 1179648
    s_lshl1_add_u32 s62, s56, s57
    s_lshl_b32 s62, s62, 7
    s_add_u32 s62, s62, s61
    s_waitcnt lgkmcnt(0)
    s_mov_b32 s32, s10
    s_mov_b32 s33, s11
    s_mov_b32 s34, 4718592
    s_mov_b32 s35, 0x20000
    buffer_load_dwordx4 v[112:115], v88, s[32:35], s62 offen nt
    buffer_load_dwordx4 v[116:119], v89, s[32:35], s62 offen nt
    buffer_load_dwordx4 v[120:123], v90, s[32:35], s62 offen nt
    buffer_load_dwordx4 v[124:127], v91, s[32:35], s62 offen nt
    s_add_u32 s62, s62, 262144
    buffer_load_dwordx4 v[128:131], v88, s[32:35], s62 offen nt
    buffer_load_dwordx4 v[132:135], v89, s[32:35], s62 offen nt
    buffer_load_dwordx4 v[136:139], v90, s[32:35], s62 offen nt
    buffer_load_dwordx4 v[140:143], v91, s[32:35], s62 offen nt
    s_add_u32 s62, s62, 262144
    buffer_load_dwordx4 v[144:147], v88, s[32:35], s62 offen nt
    buffer_load_dwordx4 v[148:151], v89, s[32:35], s62 offen nt
    buffer_load_dwordx4 v[152:155], v90, s[32:35], s62 offen nt
    buffer_load_dwordx4 v[156:159], v91, s[32:35], s62 offen nt
    s_add_u32 s62, s62, 262144
    buffer_load_dwordx4 v[160:163], v88, s[32:35], s62 offen nt
    buffer_load_dwordx4 v[164:167], v89, s[32:35], s62 offen nt
    buffer_load_dwordx4 v[168:171], v90, s[32:35], s62 offen nt
    buffer_load_dwordx4 v[172:175], v91, s[32:35], s62 offen nt
    s_add_u32 s62, s62, 262144
    buffer_load_dwordx4 v[176:179], v86, s[32:35], s62 offen nt
    buffer_load_dwordx4 v[180:183], v87, s[32:35], s62 offen nt
    s_branch L_aux
L_attn:
    s_sub_u32 s61, s61, 16384
    s_add_u32 s62, s61, 163840
    s_cmp_eq_u32 s58, 0
    s_cselect_b32 s61, s62, s61
    s_cselect_b32 s81, 21, 31
    s_cselect_b32 s78, 2, 8
    s_mov_b32 s72, -1
    s_mov_b32 s62, 0
    s_mov_b32 s63, 0x3fb8aa3b
    s_mov_b64 vcc, 0
    s_lshl_b32 s64, s57, 5
    s_add_u32 s64, s64, s56
    s_lshl2_add_u32 s64, s64, s3
    s_lshl_b32 s64, s64, 7
    s_add_u32 s83, s64, 561152
    v_mov_b32 v23, 0
    v_mov_b32 v58, 0
    s_and_b32 s75, s60, 6
    s_add_u32 s75, s75, s59
    s_and_b32 s75, s75, 7
    s_add_u32 s75, s75, 1
    s_and_b32 s75, s75, 7
    s_cmp_lt_u32 s75, 2
    s_cselect_b32 s75, 11, 14
    s_mov_b32 s44, s26
    s_mov_b32 s45, s27
    s_mov_b32 s46, 758016
    s_mov_b32 s47, 0x20000
    s_cmp_eq_u32 s58, 0
    s_cbranch_scc1 L_ffn_attn
L_loop:
    s_cmp_eq_u32 s81, 0
    s_cbranch_scc1 L_dy_1
    s_add_u32 s61, s61, 16384
    s_sub_u32 s81, s81, 1
    s_cmp_eq_u32 s81, 0
    s_cbranch_scc1 L_cl_2
L_go_3:
    s_cmp_lg_u32 s82, 0
    v_mfma_f32_16x16x32_bf16 v[24:27], v[64:67], v[4:7], 0
    v_mfma_f32_16x16x32_bf16 v[28:31], v[72:75], v[4:7], 0
    v_mfma_f32_16x16x32_bf16 v[24:27], v[68:71], v[8:11], v[24:27]
    v_mfma_f32_16x16x32_bf16 v[28:31], v[76:79], v[8:11], v[28:31]
    s_cbranch_scc1 L_sk_4
    s_cbranch_vccnz L_bw_5
    s_waitcnt vmcnt(4)
L_bw_5:
    s_waitcnt vmcnt(7)
    buffer_load_dwordx4 v[64:67], v1, s[28:31], s61 offen offset:0 nt
L_sk_4:
    s_nop 5
    v_mov_b32_dpp v36, v25 quad_perm:[1,1,3,3] row_mask:0xf bank_mask:0xf
    v_mov_b32_dpp v37, v27 quad_perm:[1,1,3,3] row_mask:0xf bank_mask:0xf
    v_mov_b32_dpp v38, v29 quad_perm:[1,1,3,3] row_mask:0xf bank_mask:0xf
    v_mov_b32_dpp v39, v31 quad_perm:[1,1,3,3] row_mask:0xf bank_mask:0xf
    v_add_f32_dpp v32, v24, v36 quad_perm:[0,0,2,2] row_mask:0xf bank_mask:0xf
    v_add_f32_dpp v33, v26, v37 quad_perm:[0,0,2,2] row_mask:0xf bank_mask:0xf
    v_add_f32_dpp v34, v28, v38 quad_perm:[0,0,2,2] row_mask:0xf bank_mask:0xf
    v_add_f32_dpp v35, v30, v39 quad_perm:[0,0,2,2] row_mask:0xf bank_mask:0xf
    v_cvt_pk_bf16_f32 v36, v32, v33
    v_lshlrev_b32 v32, 16, v36
    v_and_b32 v33, 0xffff0000, v36
    v_cvt_pk_bf16_f32 v37, v34, v35
    v_lshlrev_b32 v34, 16, v37
    v_and_b32 v35, 0xffff0000, v37
    s_cbranch_scc1 L_sk_6
    s_cbranch_vccnz L_bw_7
    s_waitcnt vmcnt(4)
L_bw_7:
    s_waitcnt vmcnt(7)
    buffer_load_dwordx4 v[68:71], v1, s[28:31], s61 offen offset:128 nt
L_sk_6:
    v_mul_f32 v32, 0x3db504f3, v32
    v_mul_f32 v33, 0x3db504f3, v33
    v_mul_f32 v34, 0x3db504f3, v34
    v_mul_f32 v35, 0x3db504f3, v35
    v_cvt_pk_bf16_f32 v36, v32, v33
    v_lshlrev_b32 v32, 16, v36
    v_and_b32 v33, 0xffff0000, v36
    v_cvt_pk_bf16_f32 v37, v34, v35
    v_lshlrev_b32 v34, 16, v37
    v_and_b32 v35, 0xffff0000, v37
    v_max3_f32 v45, v32, v33, v34
    v_max_f32 v45, v45, v35
    v_mov_b32 v46, v45
    s_nop 1
    v_permlane16_swap_b32 v45, v46
    v_max_f32 v45, v45, v46
    v_mov_b32 v46, v45
    s_nop 1
    v_permlane32_swap_b32 v45, v46
    v_max_f32 v45, v45, v46
    s_cbranch_scc1 L_sk_8
    s_cbranch_vccnz L_bw_9
    s_waitcnt vmcnt(4)
L_bw_9:
    s_waitcnt vmcnt(7)
    buffer_load_dwordx4 v[72:75], v1, s[28:31], s61 offen offset:2048 nt
L_sk_8:
    v_mul_f32 v45, s63, v45
    v_max_f32 v47, v20, v45
    v_sub_f32 v44, v20, v47
    v_fma_f32 v40, v32, s63, -v47
    v_fma_f32 v41, v33, s63, -v47
    v_fma_f32 v42, v34, s63, -v47
    v_fma_f32 v43, v35, s63, -v47
    v_exp_f32 v44, v44
    v_exp_f32 v40, v40
    v_exp_f32 v41, v41
    v_exp_f32 v42, v42
    v_exp_f32 v43, v43
    v_mov_b32 v20, v47
    v_mul_f32 v16, v16, v44
    v_mul_f32 v17, v17, v44
    v_mul_f32 v18, v18, v44
    v_mul_f32 v19, v19, v44
    v_cvt_pk_bf16_f32 v36, v40, v40
    v_cvt_pk_bf16_f32 v37, v41, v41
    v_cvt_pk_bf16_f32 v38, v42, v42
    v_cvt_pk_bf16_f32 v39, v43, v43
    s_cbranch_scc1 L_sk_10
    s_cbranch_vccnz L_bw_11
    s_waitcnt vmcnt(4)
L_bw_11:
    s_waitcnt vmcnt(7)
    buffer_load_dwordx4 v[76:79], v1, s[28:31], s61 offen offset:2176 nt
L_sk_10:
    v_add_f32 v40, v40, v41
    v_add_f32 v42, v42, v43
    v_fma_f32 v21, v21, v44, v40
    v_add_f32 v21, v21, v42
    v_and_b32 v48, v36, v12
    v_and_b32 v49, v36, v13
    v_and_b32 v50, v36, v14
    v_and_b32 v51, v36, v15
    s_nop 1
    v_mfma_f32_16x16x32_bf16 v[16:19], v[48:51], v[80:83], v[16:19]
    s_cbranch_scc1 L_sk_12
    s_cbranch_vccnz L_bw_13
    s_waitcnt vmcnt(4)
L_bw_13:
    s_waitcnt vmcnt(7)
    buffer_load_dwordx4 v[80:83], v2, s[32:35], s61 offen offset:0 nt
L_sk_12:
    v_and_b32 v52, v37, v12
    v_and_b32 v53, v37, v13
    v_and_b32 v54, v37, v14
    v_and_b32 v55, v37, v15
    s_nop 1
    v_mfma_f32_16x16x32_bf16 v[16:19], v[52:55], v[84:87], v[16:19]
    s_cbranch_scc1 L_sk_14
    s_cbranch_vccnz L_bw_15
    s_waitcnt vmcnt(4)
L_bw_15:
    s_waitcnt vmcnt(7)
    buffer_load_dwordx4 v[84:87], v2, s[32:35], s61 offen offset:1024 nt
L_sk_14:
    v_and_b32 v48, v38, v12
    v_and_b32 v49, v38, v13
    v_and_b32 v50, v38, v14
    v_and_b32 v51, v38, v15
    s_nop 1
    v_mfma_f32_16x16x32_bf16 v[16:19], v[48:51], v[88:91], v[16:19]
    s_cbranch_scc1 L_sk_16
    s_cbranch_vccnz L_bw_17
    s_waitcnt vmcnt(4)
L_bw_17:
    s_waitcnt vmcnt(7)
    buffer_load_dwordx4 v[88:91], v2, s[32:35], s61 offen offset:2048 nt
L_sk_16:
    v_and_b32 v52, v39, v12
    v_and_b32 v53, v39, v13
    v_and_b32 v54, v39, v14
    v_and_b32 v55, v39, v15
    s_nop 1
    v_mfma_f32_16x16x32_bf16 v[16:19], v[52:55], v[92:95], v[16:19]
    s_cbranch_scc1 L_sk_18
    s_cbranch_vccnz L_bw_19
    s_waitcnt vmcnt(4)
L_bw_19:
    s_waitcnt vmcnt(7)
    buffer_load_dwordx4 v[92:95], v2, s[32:35], s61 offen offset:3072 nt
L_sk_18:
    s_cmp_eq_u32 s62, 0
    s_cselect_b32 s82, 0, s82
    s_cmp_eq_u32 s72, 0
    s_cbranch_scc1 L_x0
    s_cmp_eq_u32 s72, 2
    s_cbranch_scc1 L_x2
L_xret0:
    s_cmp_eq_u32 s81, 0
    s_cbranch_scc1 L_dy_20
    s_add_u32 s61, s61, 16384
    s_sub_u32 s81, s81, 1
    s_cmp_eq_u32 s81, 0
    s_cbranch_scc1 L_cl_21
L_go_22:
    v_mfma_f32_16x16x32_bf16 v[24:27], v[96:99], v[4:7], 0
    v_mfma_f32_16x16x32_bf16 v[28:31], v[104:107], v[4:7], 0
    v_mfma_f32_16x16x32_bf16 v[24:27], v[100:103], v[8:11], v[24:27]
    v_mfma_f32_16x16x32_bf16 v[28:31], v[108:111], v[8:11], v[28:31]
    s_cbranch_vccnz L_bw_24
    s_waitcnt vmcnt(4)
L_bw_24:
    s_waitcnt vmcnt(7)
    buffer_load_dwordx4 v[96:99], v1, s[28:31], s61 offen offset:0 nt
    s_nop 5
    v_mov_b32_dpp v36, v25 quad_perm:[1,1,3,3] row_mask:0xf bank_mask:0xf
    v_mov_b32_dpp v37, v27 quad_perm:[1,1,3,3] row_mask:0xf bank_mask:0xf
    v_mov_b32_dpp v38, v29 quad_perm:[1,1,3,3] row_mask:0xf bank_mask:0xf
    v_mov_b32_dpp v39, v31 quad_perm:[1,1,3,3] row_mask:0xf bank_mask:0xf
    v_add_f32_dpp v32, v24, v36 quad_perm:[0,0,2,2] row_mask:0xf bank_mask:0xf
    v_add_f32_dpp v33, v26, v37 quad_perm:[0,0,2,2] row_mask:0xf bank_mask:0xf
    v_add_f32_dpp v34, v28, v38 quad_perm:[0,0,2,2] row_mask:0xf bank_mask:0xf
    v_add_f32_dpp v35, v30, v39 quad_perm:[0,0,2,2] row_mask:0xf bank_mask:0xf
    v_cvt_pk_bf16_f32 v36, v32, v33
    v_lshlrev_b32 v32, 16, v36
    v_and_b32 v33, 0xffff0000, v36
    v_cvt_pk_bf16_f32 v37, v34, v35
    v_lshlrev_b32 v34, 16, v37
    v_and_b32 v35, 0xffff0000, v37
    s_cbranch_vccnz L_bw_26
    s_waitcnt vmcnt(4)
L_bw_26:
    s_waitcnt vmcnt(7)
    buffer_load_dwordx4 v[100:103], v1, s[28:31], s61 offen offset:128 nt
    v_mul_f32 v32, 0x3db504f3, v32
    v_mul_f32 v33, 0x3db504f3, v33
    v_mul_f32 v34, 0x3db504f3, v34
    v_mul_f32 v35, 0x3db504f3, v35
    v_cvt_pk_bf16_f32 v36, v32, v33
    v_lshlrev_b32 v32, 16, v36
    v_and_b32 v33, 0xffff0000, v36
    v_cvt_pk_bf16_f32 v37, v34, v35
    v_lshlrev_b32 v34, 16, v37
    v_and_b32 v35, 0xffff0000, v37
    v_max3_f32 v45, v32, v33, v34
    v_max_f32 v45, v45, v35
    v_mov_b32 v46, v45
    s_nop 1
    v_permlane16_swap_b32 v45, v46
    v_max_f32 v45, v45, v46
    v_mov_b32 v46, v45
    s_nop 1
    v_permlane32_swap_b32 v45, v46
    v_max_f32 v45, v45, v46
    s_cbranch_vccnz L_bw_28
    s_waitcnt vmcnt(4)
L_bw_28:
    s_waitcnt vmcnt(7)
    buffer_load_dwordx4 v[104:107], v1, s[28:31], s61 offen offset:2048 nt
    v_mul_f32 v45, s63, v45
    v_max_f32 v47, v20, v45
    v_sub_f32 v44, v20, v47
    v_fma_f32 v40, v32, s63, -v47
    v_fma_f32 v41, v33, s63, -v47
    v_fma_f32 v42, v34, s63, -v47
    v_fma_f32 v43, v35, s63, -v47
    v_exp_f32 v44, v44
    v_exp_f32 v40, v40
    v_exp_f32 v41, v41
    v_exp_f32 v42, v42
    v_exp_f32 v43, v43
    v_mov_b32 v20, v47
    v_mul_f32 v16, v16, v44
    v_mul_f32 v17, v17, v44
    v_mul_f32 v18, v18, v44
    v_mul_f32 v19, v19, v44
    v_cvt_pk_bf16_f32 v36, v40, v40
    v_cvt_pk_bf16_f32 v37, v41, v41
    v_cvt_pk_bf16_f32 v38, v42, v42
    v_cvt_pk_bf16_f32 v39, v43, v43
    s_cbranch_vccnz L_bw_30
    s_waitcnt vmcnt(4)
L_bw_30:
    s_waitcnt vmcnt(7)
    buffer_load_dwordx4 v[108:111], v1, s[28:31], s61 offen offset:2176 nt
    v_add_f32 v40, v40, v41
    v_add_f32 v42, v42, v43
    v_fma_f32 v21, v21, v44, v40
    v_add_f32 v21, v21, v42
    v_and_b32 v48, v36, v12
    v_and_b32 v49, v36, v13
    v_and_b32 v50, v36, v14
    v_and_b32 v51, v36, v15
    s_nop 1
    v_mfma_f32_16x16x32_bf16 v[16:19], v[48:51], v[112:115], v[16:19]
    s_cbranch_vccnz L_bw_32
    s_waitcnt vmcnt(4)
L_bw_32:
    s_waitcnt vmcnt(7)
    buffer_load_dwordx4 v[112:115], v2, s[32:35], s61 offen offset:0 nt
    v_and_b32 v52, v37, v12
    v_and_b32 v53, v37, v13
    v_and_b32 v54, v37, v14
    v_and_b32 v55, v37, v15
    s_nop 1
    v_mfma_f32_16x16x32_bf16 v[16:19], v[52:55], v[116:119], v[16:19]
    s_cbranch_vccnz L_bw_34
    s_waitcnt vmcnt(4)
L_bw_34:
    s_waitcnt vmcnt(7)
    buffer_load_dwordx4 v[116:119], v2, s[32:35], s61 offen offset:1024 nt
    v_and_b32 v48, v38, v12
    v_and_b32 v49, v38, v13
    v_and_b32 v50, v38, v14
    v_and_b32 v51, v38, v15
    s_nop 1
    v_mfma_f32_16x16x32_bf16 v[16:19], v[48:51], v[120:123], v[16:19]
    s_cbranch_vccnz L_bw_36
    s_waitcnt vmcnt(4)
L_bw_36:
    s_waitcnt vmcnt(7)
    buffer_load_dwordx4 v[120:123], v2, s[32:35], s61 offen offset:2048 nt
    v_and_b32 v52, v39, v12
    v_and_b32 v53, v39, v13
    v_and_b32 v54, v39, v14
    v_and_b32 v55, v39, v15
    s_nop 1
    v_mfma_f32_16x16x32_bf16 v[16:19], v[52:55], v[124:127], v[16:19]
    s_cbranch_vccnz L_bw_38
    s_waitcnt vmcnt(4)
L_bw_38:
    s_waitcnt vmcnt(7)
    buffer_load_dwordx4 v[124:127], v2, s[32:35], s61 offen offset:3072 nt
    s_cmp_eq_u32 s72, 1
    s_cbranch_scc1 L_x1
    s_cmp_eq_u32 s72, 3
    s_cbranch_scc1 L_x3
L_xret1:
    s_cmp_eq_u32 s62, 0
    s_cbranch_scc1 L_pass0
    s_add_u32 s62, s62, 1
    s_cmp_lg_u32 s62, 3
    s_cbranch_scc1 L_nopb
    s_mov_b64 vcc, 0
L_nopb:
    s_cmp_lg_u32 s62, s78
    s_cbranch_scc1 L_loop
    s_barrier
    s_branch L_loop
L_pass0:
    s_cmp_eq_u32 s58, 0
    s_cbranch_scc1 L_qwait
L_x0:
    s_cmp_lg_u32 s62, 0
    s_cbranch_scc1 L_xa_39
    s_add_u32 s61, s61, 16384
    s_sub_u32 s81, s81, 1
L_xa_39:
    s_cmp_lg_u32 s62, 0
    v_mfma_f32_16x16x32_bf16 v[24:27], v[128:131], v[4:7], 0
    v_mfma_f32_16x16x32_bf16 v[28:31], v[136:139], v[4:7], 0
    v_mfma_f32_16x16x32_bf16 v[24:27], v[132:135], v[8:11], v[24:27]
    v_mfma_f32_16x16x32_bf16 v[28:31], v[140:143], v[8:11], v[28:31]
    s_cbranch_scc1 L_sk_40
    s_waitcnt vmcnt(5)
    buffer_load_dwordx4 v[128:131], v1, s[28:31], s61 offen offset:0 nt
L_sk_40:
    s_nop 5
    v_mov_b32_dpp v36, v25 quad_perm:[1,1,3,3] row_mask:0xf bank_mask:0xf
    v_mov_b32_dpp v37, v27 quad_perm:[1,1,3,3] row_mask:0xf bank_mask:0xf
    v_mov_b32_dpp v38, v29 quad_perm:[1,1,3,3] row_mask:0xf bank_mask:0xf
    v_mov_b32_dpp v39, v31 quad_perm:[1,1,3,3] row_mask:0xf bank_mask:0xf
    v_add_f32_dpp v32, v24, v36 quad_perm:[0,0,2,2] row_mask:0xf bank_mask:0xf
    v_add_f32_dpp v33, v26, v37 quad_perm:[0,0,2,2] row_mask:0xf bank_mask:0xf
    v_add_f32_dpp v34, v28, v38 quad_perm:[0,0,2,2] row_mask:0xf bank_mask:0xf
    v_add_f32_dpp v35, v30, v39 quad_perm:[0,0,2,2] row_mask:0xf bank_mask:0xf
    v_cvt_pk_bf16_f32 v36, v32, v33
    v_lshlrev_b32 v32, 16, v36
    v_and_b32 v33, 0xffff0000, v36
    v_cvt_pk_bf16_f32 v37, v34, v35
    v_lshlrev_b32 v34, 16, v37
    v_and_b32 v35, 0xffff0000, v37
    s_cbranch_scc1 L_sk_41
    s_waitcnt vmcnt(5)
    buffer_load_dwordx4 v[132:135], v1, s[28:31], s61 offen offset:128 nt
L_sk_41:
    v_mul_f32 v32, 0x3db504f3, v32
    v_mul_f32 v33, 0x3db504f3, v33
    v_mul_f32 v34, 0x3db504f3, v34
    v_mul_f32 v35, 0x3db504f3, v35
    v_cvt_pk_bf16_f32 v36, v32, v33
    v_lshlrev_b32 v32, 16, v36
    v_and_b32 v33, 0xffff0000, v36
    v_cvt_pk_bf16_f32 v37, v34, v35
    v_lshlrev_b32 v34, 16, v37
    v_and_b32 v35, 0xffff0000, v37
    v_max3_f32 v45, v32, v33, v34
    v_max_f32 v45, v45, v35
    v_mov_b32 v46, v45
    s_nop 1
    v_permlane16_swap_b32 v45, v46
    v_max_f32 v45, v45, v46
    v_mov_b32 v46, v45
    s_nop 1
    v_permlane32_swap_b32 v45, v46
    v_max_f32 v45, v45, v46
    s_cbranch_scc1 L_sk_42
    s_waitcnt vmcnt(5)
    buffer_load_dwordx4 v[136:139], v1, s[28:31], s61 offen offset:2048 nt
L_sk_42:
    v_mul_f32 v45, s63, v45
    v_max_f32 v47, v20, v45
    v_sub_f32 v44, v20, v47
    v_fma_f32 v40, v32, s63, -v47
    v_fma_f32 v41, v33, s63, -v47
    v_fma_f32 v42, v34, s63, -v47
    v_fma_f32 v43, v35, s63, -v47
    v_exp_f32 v44, v44
    v_exp_f32 v40, v40
    v_exp_f32 v41, v41
    v_exp_f32 v42, v42
    v_exp_f32 v43, v43
    v_mov_b32 v20, v47
    v_mul_f32 v16, v16, v44
    v_mul_f32 v17, v17, v44
    v_mul_f32 v18, v18, v44
    v_mul_f32 v19, v19, v44
    v_cvt_pk_bf16_f32 v36, v40, v40
    v_cvt_pk_bf16_f32 v37, v41, v41
    v_cvt_pk_bf16_f32 v38, v42, v42
    v_cvt_pk_bf16_f32 v39, v43, v43
    s_cbranch_scc1 L_sk_43
    s_waitcnt vmcnt(5)
    buffer_load_dwordx4 v[140:143], v1, s[28:31], s61 offen offset:2176 nt
L_sk_43:
    v_add_f32 v40, v40, v41
    v_add_f32 v42, v42, v43
    v_fma_f32 v21, v21, v44, v40
    v_add_f32 v21, v21, v42
    v_and_b32 v48, v36, v12
    v_and_b32 v49, v36, v13
    v_and_b32 v50, v36, v14
    v_and_b32 v51, v36, v15
    s_nop 1
    v_mfma_f32_16x16x32_bf16 v[16:19], v[48:51], v[144:147], v[16:19]
    s_cbranch_scc1 L_sk_44
    s_waitcnt vmcnt(5)
    buffer_load_dwordx4 v[144:147], v2, s[32:35], s61 offen offset:0 nt
L_sk_44:
    v_and_b32 v52, v37, v12
    v_and_b32 v53, v37, v13
    v_and_b32 v54, v37, v14
    v_and_b32 v55, v37, v15
    s_nop 1
    v_mfma_f32_16x16x32_bf16 v[16:19], v[52:55], v[148:151], v[16:19]
    s_cbranch_scc1 L_sk_45
    s_waitcnt vmcnt(5)
    buffer_load_dwordx4 v[148:151], v2, s[32:35], s61 offen offset:1024 nt
L_sk_45:
    v_and_b32 v48, v38, v12
    v_and_b32 v49, v38, v13
    v_and_b32 v50, v38, v14
    v_and_b32 v51, v38, v15
    s_nop 1
    v_mfma_f32_16x16x32_bf16 v[16:19], v[48:51], v[152:155], v[16:19]
    s_cbranch_scc1 L_sk_46
    s_waitcnt vmcnt(5)
    buffer_load_dwordx4 v[152:155], v2, s[32:35], s61 offen offset:2048 nt
L_sk_46:
    v_and_b32 v52, v39, v12
    v_and_b32 v53, v39, v13
    v_and_b32 v54, v39, v14
    v_and_b32 v55, v39, v15
    s_nop 1
    v_mfma_f32_16x16x32_bf16 v[16:19], v[52:55], v[156:159], v[16:19]
    s_cbranch_scc1 L_sk_47
    s_waitcnt vmcnt(5)
    buffer_load_dwordx4 v[156:159], v2, s[32:35], s61 offen offset:3072 nt
L_sk_47:
    s_cbranch_scc0 L_xn_48
    s_add_u32 s72, s72, 1
    s_branch L_xret0
L_xn_48:
L_x1:
    s_cmp_lg_u32 s62, 0
    s_cbranch_scc1 L_xa_49
    s_add_u32 s61, s61, 16384
    s_sub_u32 s81, s81, 1
L_xa_49:
    s_cmp_lg_u32 s62, 0
    v_mfma_f32_16x16x32_bf16 v[24:27], v[160:163], v[4:7], 0
    v_mfma_f32_16x16x32_bf16 v[28:31], v[168:171], v[4:7], 0
    v_mfma_f32_16x16x32_bf16 v[24:27], v[164:167], v[8:11], v[24:27]
    v_mfma_f32_16x16x32_bf16 v[28:31], v[172:175], v[8:11], v[28:31]
    s_cbranch_scc1 L_sk_50
    s_waitcnt vmcnt(5)
    buffer_load_dwordx4 v[160:163], v1, s[28:31], s61 offen offset:0 nt
L_sk_50:
    s_nop 5
    v_mov_b32_dpp v36, v25 quad_perm:[1,1,3,3] row_mask:0xf bank_mask:0xf
    v_mov_b32_dpp v37, v27 quad_perm:[1,1,3,3] row_mask:0xf bank_mask:0xf
    v_mov_b32_dpp v38, v29 quad_perm:[1,1,3,3] row_mask:0xf bank_mask:0xf
    v_mov_b32_dpp v39, v31 quad_perm:[1,1,3,3] row_mask:0xf bank_mask:0xf
    v_add_f32_dpp v32, v24, v36 quad_perm:[0,0,2,2] row_mask:0xf bank_mask:0xf
    v_add_f32_dpp v33, v26, v37 quad_perm:[0,0,2,2] row_mask:0xf bank_mask:0xf
    v_add_f32_dpp v34, v28, v38 quad_perm:[0,0,2,2] row_mask:0xf bank_mask:0xf
    v_add_f32_dpp v35, v30, v39 quad_perm:[0,0,2,2] row_mask:0xf bank_mask:0xf
    v_cvt_pk_bf16_f32 v36, v32, v33
    v_lshlrev_b32 v32, 16, v36
    v_and_b32 v33, 0xffff0000, v36
    v_cvt_pk_bf16_f32 v37, v34, v35
    v_lshlrev_b32 v34, 16, v37
    v_and_b32 v35, 0xffff0000, v37
    s_cbranch_scc1 L_sk_51
    s_waitcnt vmcnt(5)
    buffer_load_dwordx4 v[164:167], v1, s[28:31], s61 offen offset:128 nt
L_sk_51:
    v_mul_f32 v32, 0x3db504f3, v32
    v_mul_f32 v33, 0x3db504f3, v33
    v_mul_f32 v34, 0x3db504f3, v34
    v_mul_f32 v35, 0x3db504f3, v35
    v_cvt_pk_bf16_f32 v36, v32, v33
    v_lshlrev_b32 v32, 16, v36
    v_and_b32 v33, 0xffff0000, v36
    v_cvt_pk_bf16_f32 v37, v34, v35
    v_lshlrev_b32 v34, 16, v37
    v_and_b32 v35, 0xffff0000, v37
    v_max3_f32 v45, v32, v33, v34
    v_max_f32 v45, v45, v35
    v_mov_b32 v46, v45
    s_nop 1
    v_permlane16_swap_b32 v45, v46
    v_max_f32 v45, v45, v46
    v_mov_b32 v46, v45
    s_nop 1
    v_permlane32_swap_b32 v45, v46
    v_max_f32 v45, v45, v46
    s_cbranch_scc1 L_sk_52
    s_waitcnt vmcnt(5)
    buffer_load_dwordx4 v[168:171], v1, s[28:31], s61 offen offset:2048 nt
L_sk_52:
    v_mul_f32 v45, s63, v45
    v_max_f32 v47, v20, v45
    v_sub_f32 v44, v20, v47
    v_fma_f32 v40, v32, s63, -v47
    v_fma_f32 v41, v33, s63, -v47
    v_fma_f32 v42, v34, s63, -v47
    v_fma_f32 v43, v35, s63, -v47
    v_exp_f32 v44, v44
    v_exp_f32 v40, v40
    v_exp_f32 v41, v41
    v_exp_f32 v42, v42
    v_exp_f32 v43, v43
    v_mov_b32 v20, v47
    v_mul_f32 v16, v16, v44
    v_mul_f32 v17, v17, v44
    v_mul_f32 v18, v18, v44
    v_mul_f32 v19, v19, v44
    v_cvt_pk_bf16_f32 v36, v40, v40
    v_cvt_pk_bf16_f32 v37, v41, v41
    v_cvt_pk_bf16_f32 v38, v42, v42
    v_cvt_pk_bf16_f32 v39, v43, v43
    s_cbranch_scc1 L_sk_53
    s_waitcnt vmcnt(5)
    buffer_load_dwordx4 v[172:175], v1, s[28:31], s61 offen offset:2176 nt
L_sk_53:
    v_add_f32 v40, v40, v41
    v_add_f32 v42, v42, v43
    v_fma_f32 v21, v21, v44, v40
    v_add_f32 v21, v21, v42
    v_and_b32 v48, v36, v12
    v_and_b32 v49, v36, v13
    v_and_b32 v50, v36, v14
    v_and_b32 v51, v36, v15
    s_nop 1
    v_mfma_f32_16x16x32_bf16 v[16:19], v[48:51], v[176:179], v[16:19]
    s_cbranch_scc1 L_sk_54
    s_waitcnt vmcnt(5)
    buffer_load_dwordx4 v[176:179], v2, s[32:35], s61 offen offset:0 nt
L_sk_54:
    v_and_b32 v52, v37, v12
    v_and_b32 v53, v37, v13
    v_and_b32 v54, v37, v14
    v_and_b32 v55, v37, v15
    s_nop 1
    v_mfma_f32_16x16x32_bf16 v[16:19], v[52:55], v[180:183], v[16:19]
    s_cbranch_scc1 L_sk_55
    s_waitcnt vmcnt(5)
    buffer_load_dwordx4 v[180:183], v2, s[32:35], s61 offen offset:1024 nt
L_sk_55:
    v_and_b32 v48, v38, v12
    v_and_b32 v49, v38, v13
    v_and_b32 v50, v38, v14
    v_and_b32 v51, v38, v15
    s_nop 1
    v_mfma_f32_16x16x32_bf16 v[16:19], v[48:51], v[184:187], v[16:19]
    s_cbranch_scc1 L_sk_56
    s_waitcnt vmcnt(5)
    buffer_load_dwordx4 v[184:187], v2, s[32:35], s61 offen offset:2048 nt
L_sk_56:
    v_and_b32 v52, v39, v12
    v_and_b32 v53, v39, v13
    v_and_b32 v54, v39, v14
    v_and_b32 v55, v39, v15
    s_nop 1
    v_mfma_f32_16x16x32_bf16 v[16:19], v[52:55], v[188:191], v[16:19]
    s_cbranch_scc1 L_sk_57
    s_waitcnt vmcnt(5)
    buffer_load_dwordx4 v[188:191], v2, s[32:35], s61 offen offset:3072 nt
L_sk_57:
    s_cbranch_scc0 L_xn_58
    s_add_u32 s72, s72, 1
    s_branch L_xret1
L_xn_58:
L_x2:
    s_cmp_lg_u32 s62, 0
    s_cbranch_scc1 L_xa_59
    s_add_u32 s61, s61, 16384
    s_sub_u32 s81, s81, 1
L_xa_59:
    s_cmp_lg_u32 s62, 0
    v_mfma_f32_16x16x32_bf16 v[24:27], v[192:195], v[4:7], 0
    v_mfma_f32_16x16x32_bf16 v[28:31], v[200:203], v[4:7], 0
    v_mfma_f32_16x16x32_bf16 v[24:27], v[196:199], v[8:11], v[24:27]
    v_mfma_f32_16x16x32_bf16 v[28:31], v[204:207], v[8:11], v[28:31]
    s_cbranch_scc1 L_sk_60
    s_waitcnt vmcnt(5)
    buffer_load_dwordx4 v[192:195], v1, s[28:31], s61 offen offset:0 nt
L_sk_60:
    s_nop 5
    v_mov_b32_dpp v36, v25 quad_perm:[1,1,3,3] row_mask:0xf bank_mask:0xf
    v_mov_b32_dpp v37, v27 quad_perm:[1,1,3,3] row_mask:0xf bank_mask:0xf
    v_mov_b32_dpp v38, v29 quad_perm:[1,1,3,3] row_mask:0xf bank_mask:0xf
    v_mov_b32_dpp v39, v31 quad_perm:[1,1,3,3] row_mask:0xf bank_mask:0xf
    v_add_f32_dpp v32, v24, v36 quad_perm:[0,0,2,2] row_mask:0xf bank_mask:0xf
    v_add_f32_dpp v33, v26, v37 quad_perm:[0,0,2,2] row_mask:0xf bank_mask:0xf
    v_add_f32_dpp v34, v28, v38 quad_perm:[0,0,2,2] row_mask:0xf bank_mask:0xf
    v_add_f32_dpp v35, v30, v39 quad_perm:[0,0,2,2] row_mask:0xf bank_mask:0xf
    v_cvt_pk_bf16_f32 v36, v32, v33
    v_lshlrev_b32 v32, 16, v36
    v_and_b32 v33, 0xffff0000, v36
    v_cvt_pk_bf16_f32 v37, v34, v35
    v_lshlrev_b32 v34, 16, v37
    v_and_b32 v35, 0xffff0000, v37
    s_cbranch_scc1 L_sk_61
    s_waitcnt vmcnt(5)
    buffer_load_dwordx4 v[196:199], v1, s[28:31], s61 offen offset:128 nt
L_sk_61:
    v_mul_f32 v32, 0x3db504f3, v32
    v_mul_f32 v33, 0x3db504f3, v33
    v_mul_f32 v34, 0x3db504f3, v34
    v_mul_f32 v35, 0x3db504f3, v35
    v_cvt_pk_bf16_f32 v36, v32, v33
    v_lshlrev_b32 v32, 16, v36
    v_and_b32 v33, 0xffff0000, v36
    v_cvt_pk_bf16_f32 v37, v34, v35
    v_lshlrev_b32 v34, 16, v37
    v_and_b32 v35, 0xffff0000, v37
    v_max3_f32 v45, v32, v33, v34
    v_max_f32 v45, v45, v35
    v_mov_b32 v46, v45
    s_nop 1
    v_permlane16_swap_b32 v45, v46
    v_max_f32 v45, v45, v46
    v_mov_b32 v46, v45
    s_nop 1
    v_permlane32_swap_b32 v45, v46
    v_max_f32 v45, v45, v46
    s_cbranch_scc1 L_sk_62
    s_waitcnt vmcnt(5)
    buffer_load_dwordx4 v[200:203], v1, s[28:31], s61 offen offset:2048 nt
L_sk_62:
    v_mul_f32 v45, s63, v45
    v_max_f32 v47, v20, v45
    v_sub_f32 v44, v20, v47
    v_fma_f32 v40, v32, s63, -v47
    v_fma_f32 v41, v33, s63, -v47
    v_fma_f32 v42, v34, s63, -v47
    v_fma_f32 v43, v35, s63, -v47
    v_exp_f32 v44, v44
    v_exp_f32 v40, v40
    v_exp_f32 v41, v41
    v_exp_f32 v42, v42
    v_exp_f32 v43, v43
    v_mov_b32 v20, v47
    v_mul_f32 v16, v16, v44
    v_mul_f32 v17, v17, v44
    v_mul_f32 v18, v18, v44
    v_mul_f32 v19, v19, v44
    v_cvt_pk_bf16_f32 v36, v40, v40
    v_cvt_pk_bf16_f32 v37, v41, v41
    v_cvt_pk_bf16_f32 v38, v42, v42
    v_cvt_pk_bf16_f32 v39, v43, v43
    s_cbranch_scc1 L_sk_63
    s_waitcnt vmcnt(5)
    buffer_load_dwordx4 v[204:207], v1, s[28:31], s61 offen offset:2176 nt
L_sk_63:
    v_add_f32 v40, v40, v41
    v_add_f32 v42, v42, v43
    v_fma_f32 v21, v21, v44, v40
    v_add_f32 v21, v21, v42
    v_and_b32 v48, v36, v12
    v_and_b32 v49, v36, v13
    v_and_b32 v50, v36, v14
    v_and_b32 v51, v36, v15
    s_nop 1
    v_mfma_f32_16x16x32_bf16 v[16:19], v[48:51], v[208:211], v[16:19]
    s_cbranch_scc1 L_sk_64
    s_waitcnt vmcnt(5)
    buffer_load_dwordx4 v[208:211], v2, s[32:35], s61 offen offset:0 nt
L_sk_64:
    v_and_b32 v52, v37, v12
    v_and_b32 v53, v37, v13
    v_and_b32 v54, v37, v14
    v_and_b32 v55, v37, v15
    s_nop 1
    v_mfma_f32_16x16x32_bf16 v[16:19], v[52:55], v[212:215], v[16:19]
    s_cbranch_scc1 L_sk_65
    s_waitcnt vmcnt(5)
    buffer_load_dwordx4 v[212:215], v2, s[32:35], s61 offen offset:1024 nt
L_sk_65:
    v_and_b32 v48, v38, v12
    v_and_b32 v49, v38, v13
    v_and_b32 v50, v38, v14
    v_and_b32 v51, v38, v15
    s_nop 1
    v_mfma_f32_16x16x32_bf16 v[16:19], v[48:51], v[216:219], v[16:19]
    s_cbranch_scc1 L_sk_66
    s_waitcnt vmcnt(5)
    buffer_load_dwordx4 v[216:219], v2, s[32:35], s61 offen offset:2048 nt
L_sk_66:
    v_and_b32 v52, v39, v12
    v_and_b32 v53, v39, v13
    v_and_b32 v54, v39, v14
    v_and_b32 v55, v39, v15
    s_nop 1
    v_mfma_f32_16x16x32_bf16 v[16:19], v[52:55], v[220:223], v[16:19]
    s_cbranch_scc1 L_sk_67
    s_waitcnt vmcnt(5)
    buffer_load_dwordx4 v[220:223], v2, s[32:35], s61 offen offset:3072 nt
L_sk_67:
    s_cbranch_scc0 L_xn_68
    s_add_u32 s72, s72, 1
    s_branch L_xret0
L_xn_68:
L_x3:
    s_cmp_lg_u32 s62, 0
    s_cbranch_scc1 L_xa_69
    s_barrier
    s_add_u32 s61, s61, 16384
    s_sub_u32 s81, s81, 1
L_xa_69:
    s_cmp_lg_u32 s62, 0
    v_mfma_f32_16x16x32_bf16 v[24:27], v[224:227], v[4:7], 0
    v_mfma_f32_16x16x32_bf16 v[28:31], v[232:235], v[4:7], 0
    v_mfma_f32_16x16x32_bf16 v[24:27], v[228:231], v[8:11], v[24:27]
    v_mfma_f32_16x16x32_bf16 v[28:31], v[236:239], v[8:11], v[28:31]
    s_cbranch_scc1 L_sk_70
    s_waitcnt vmcnt(5)
    buffer_load_dwordx4 v[224:227], v1, s[28:31], s61 offen offset:0 nt
L_sk_70:
    s_nop 5
    v_mov_b32_dpp v36, v25 quad_perm:[1,1,3,3] row_mask:0xf bank_mask:0xf
    v_mov_b32_dpp v37, v27 quad_perm:[1,1,3,3] row_mask:0xf bank_mask:0xf
    v_mov_b32_dpp v38, v29 quad_perm:[1,1,3,3] row_mask:0xf bank_mask:0xf
    v_mov_b32_dpp v39, v31 quad_perm:[1,1,3,3] row_mask:0xf bank_mask:0xf
    v_add_f32_dpp v32, v24, v36 quad_perm:[0,0,2,2] row_mask:0xf bank_mask:0xf
    v_add_f32_dpp v33, v26, v37 quad_perm:[0,0,2,2] row_mask:0xf bank_mask:0xf
    v_add_f32_dpp v34, v28, v38 quad_perm:[0,0,2,2] row_mask:0xf bank_mask:0xf
    v_add_f32_dpp v35, v30, v39 quad_perm:[0,0,2,2] row_mask:0xf bank_mask:0xf
    v_cvt_pk_bf16_f32 v36, v32, v33
    v_lshlrev_b32 v32, 16, v36
    v_and_b32 v33, 0xffff0000, v36
    v_cvt_pk_bf16_f32 v37, v34, v35
    v_lshlrev_b32 v34, 16, v37
    v_and_b32 v35, 0xffff0000, v37
    s_cbranch_scc1 L_sk_71
    s_waitcnt vmcnt(5)
    buffer_load_dwordx4 v[228:231], v1, s[28:31], s61 offen offset:128 nt
L_sk_71:
    v_mul_f32 v32, 0x3db504f3, v32
    v_mul_f32 v33, 0x3db504f3, v33
    v_mul_f32 v34, 0x3db504f3, v34
    v_mul_f32 v35, 0x3db504f3, v35
    v_cvt_pk_bf16_f32 v36, v32, v33
    v_lshlrev_b32 v32, 16, v36
    v_and_b32 v33, 0xffff0000, v36
    v_cvt_pk_bf16_f32 v37, v34, v35
    v_lshlrev_b32 v34, 16, v37
    v_and_b32 v35, 0xffff0000, v37
    v_max3_f32 v45, v32, v33, v34
    v_max_f32 v45, v45, v35
    v_mov_b32 v46, v45
    s_nop 1
    v_permlane16_swap_b32 v45, v46
    v_max_f32 v45, v45, v46
    v_mov_b32 v46, v45
    s_nop 1
    v_permlane32_swap_b32 v45, v46
    v_max_f32 v45, v45, v46
    s_cbranch_scc1 L_sk_72
    s_waitcnt vmcnt(5)
    buffer_load_dwordx4 v[232:235], v1, s[28:31], s61 offen offset:2048 nt
L_sk_72:
    v_mul_f32 v45, s63, v45
    v_max_f32 v47, v20, v45
    v_sub_f32 v44, v20, v47
    v_fma_f32 v40, v32, s63, -v47
    v_fma_f32 v41, v33, s63, -v47
    v_fma_f32 v42, v34, s63, -v47
    v_fma_f32 v43, v35, s63, -v47
    v_exp_f32 v44, v44
    v_exp_f32 v40, v40
    v_exp_f32 v41, v41
    v_exp_f32 v42, v42
    v_exp_f32 v43, v43
    v_mov_b32 v20, v47
    v_mul_f32 v16, v16, v44
    v_mul_f32 v17, v17, v44
    v_mul_f32 v18, v18, v44
    v_mul_f32 v19, v19, v44
    v_cvt_pk_bf16_f32 v36, v40, v40
    v_cvt_pk_bf16_f32 v37, v41, v41
    v_cvt_pk_bf16_f32 v38, v42, v42
    v_cvt_pk_bf16_f32 v39, v43, v43
    s_cbranch_scc1 L_sk_73
    s_waitcnt vmcnt(5)
    buffer_load_dwordx4 v[236:239], v1, s[28:31], s61 offen offset:2176 nt
L_sk_73:
    v_add_f32 v40, v40, v41
    v_add_f32 v42, v42, v43
    v_fma_f32 v21, v21, v44, v40
    v_add_f32 v21, v21, v42
    v_and_b32 v48, v36, v12
    v_and_b32 v49, v36, v13
    v_and_b32 v50, v36, v14
    v_and_b32 v51, v36, v15
    s_nop 1
    v_mfma_f32_16x16x32_bf16 v[16:19], v[48:51], v[240:243], v[16:19]
    s_cbranch_scc1 L_sk_74
    s_waitcnt vmcnt(5)
    buffer_load_dwordx4 v[240:243], v2, s[32:35], s61 offen offset:0 nt
L_sk_74:
    v_and_b32 v52, v37, v12
    v_and_b32 v53, v37, v13
    v_and_b32 v54, v37, v14
    v_and_b32 v55, v37, v15
    s_nop 1
    v_mfma_f32_16x16x32_bf16 v[16:19], v[52:55], v[244:247], v[16:19]
    s_cbranch_scc1 L_sk_75
    s_waitcnt vmcnt(5)
    buffer_load_dwordx4 v[244:247], v2, s[32:35], s61 offen offset:1024 nt
L_sk_75:
    v_and_b32 v48, v38, v12
    v_and_b32 v49, v38, v13
    v_and_b32 v50, v38, v14
    v_and_b32 v51, v38, v15
    s_nop 1
    v_mfma_f32_16x16x32_bf16 v[16:19], v[48:51], v[248:251], v[16:19]
    s_cbranch_scc1 L_sk_76
    s_waitcnt vmcnt(5)
    buffer_load_dwordx4 v[248:251], v2, s[32:35], s61 offen offset:2048 nt
L_sk_76:
    v_and_b32 v52, v39, v12
    v_and_b32 v53, v39, v13
    v_and_b32 v54, v39, v14
    v_and_b32 v55, v39, v15
    s_nop 1
    v_mfma_f32_16x16x32_bf16 v[16:19], v[52:55], v[252:255], v[16:19]
    s_cbranch_scc1 L_sk_77
    s_waitcnt vmcnt(5)
    buffer_load_dwordx4 v[252:255], v2, s[32:35], s61 offen offset:3072 nt
L_sk_77:
    s_cbranch_scc0 L_xn_78
    s_add_u32 s72, s72, 1
    s_branch L_xret1
L_xn_78:
    s_mov_b32 s72, 0
    s_branch L_qwait
L_dy_1:
    s_waitcnt vmcnt(8)
    v_readfirstlane_b32 s64, v22
    s_nop 0
    s_cmp_ge_u32 s64, 14
    s_cbranch_scc1 L_t1_80
    s_and_b32 s65, s64, 3
    s_lshl_b32 s65, s65, 5
    s_lshr_b32 s66, s64, 2
    s_add_u32 s65, s65, s66
    s_add_u32 s65, s65, 31
    s_sub_u32 s66, s64, 4
    s_cmp_lt_u32 s64, 4
    s_cselect_b32 s65, s65, s66
    s_lshl_b32 s65, s65, 14
    s_add_u32 s61, s80, s65
    s_cmp_lt_u32 s64, s75
    s_cbranch_scc1 L_cl_2
    v_mov_b32 v22, 14
    s_branch L_go_3
L_cl_2:
    v_mov_b32 v22, 1
    s_mov_b64 exec, 1
    buffer_atomic_add v22, v23, s[44:47], s83 offen sc0 sc1
    s_mov_b64 exec, -1
    s_mov_b64 vcc, -1
    s_branch L_go_3
L_t1_80:
    s_barrier
    s_branch L_drain0
L_dy_20:
    s_waitcnt vmcnt(8)
    v_readfirstlane_b32 s64, v22
    s_nop 0
    s_cmp_ge_u32 s64, 14
    s_cbranch_scc1 L_t1_83
    s_and_b32 s65, s64, 3
    s_lshl_b32 s65, s65, 5
    s_lshr_b32 s66, s64, 2
    s_add_u32 s65, s65, s66
    s_add_u32 s65, s65, 31
    s_sub_u32 s66, s64, 4
    s_cmp_lt_u32 s64, 4
    s_cselect_b32 s65, s65, s66
    s_lshl_b32 s65, s65, 14
    s_add_u32 s61, s80, s65
    s_cmp_lt_u32 s64, s75
    s_cbranch_scc1 L_cl_21
    v_mov_b32 v22, 14
    s_branch L_go_22
L_cl_21:
    v_mov_b32 v22, 1
    s_mov_b64 exec, 1
    buffer_atomic_add v22, v23, s[44:47], s83 offen sc0 sc1
    s_mov_b64 exec, -1
    s_mov_b64 vcc, -1
    s_branch L_go_22
L_t1_83:
    s_barrier
    s_branch L_drain1
L_qwait:
    s_load_dword s73, s[26:27], 626820
    s_mov_b32 s62, 1
    s_cmp_lg_u32 s58, 0
    s_cselect_b64 vcc, -1, 0
    v_and_b32 v58, 1, v0
    v_lshlrev_b32 v58, 4, v58
    v_mov_b32 v59, 0xffff
    v_lshlrev_b32 v58, v58, v59
    v_bfe_u32 v59, v0, 1, 2
    v_cmp_eq_u32 s[76:77], 0, v59
    s_nop 1
    v_cndmask_b32 v12, 0, v58, s[76:77]
    v_cmp_eq_u32 s[76:77], 1, v59
    s_nop 1
    v_cndmask_b32 v13, 0, v58, s[76:77]
    v_cmp_eq_u32 s[76:77], 2, v59
    s_nop 1
    v_cndmask_b32 v14, 0, v58, s[76:77]
    v_cmp_eq_u32 s[76:77], 3, v59
    s_nop 1
    v_cndmask_b32 v15, 0, v58, s[76:77]
    v_and_b32 v58, 15, v0
    v_lshlrev_b32 v56, 5, v58
    v_bfe_u32 v59, v0, 4, 1
    v_lshl_add_u32 v56, v59, 4, v56
    s_lshl_b32 s64, s3, 9
    s_add_u32 s64, s64, 6912
    v_add_u32 v56, s64, v56
    s_lshl_b32 s64, s3, 2
    s_add_u32 s64, s64, 8960
    v_mov_b32 v57, s64
    v_and_b32 v60, 1, v0
    v_lshlrev_b32 v60, 6, v60
    v_lshrrev_b32 v61, 4, v0
    v_lshl_add_u32 v60, v61, 4, v60
    v_lshlrev_b32 v58, 3, v0
    s_lshl1_add_u32 s64, s56, s57
    s_lshl2_add_u32 s64, s64, s58
    s_lshl_b32 s64, s64, 9
    s_add_u32 s49, s64, 196608
    v_mov_b32 v20, 0xff800000
    v_mov_b32 v21, 0
    v_mov_b32 v16, 0
    v_mov_b32 v17, 0
    v_mov_b32 v18, 0
    v_mov_b32 v19, 0
    s_barrier
    ds_read_b128 v[4:7], v60 offset:6656
    ds_read_b128 v[8:11], v60 offset:6784
    s_waitcnt lgkmcnt(0)
    s_add_u32 s73, s73, 0x9e3779b1
    s_branch L_loop
L_ffn_attn:
    s_mov_b32 s65, s61
    s_cmp_gt_u32 s3, 1
    s_cbranch_scc1 L_fa2
    s_mov_b32 s79, 1
    s_branch L_ln
L_ln_again:
    s_mov_b32 s79, 0
    s_waitcnt vmcnt(0)
    v_mov_b32 v4, v96
    v_mov_b32 v5, v97
    v_mov_b32 v6, v98
    v_mov_b32 v7, v99
    v_mov_b32 v8, v100
L_ln:
    v_lshlrev_b32 v16, 16, v4
    v_and_b32 v17, 0xffff0000, v4
    v_lshlrev_b32 v18, 16, v5
    v_and_b32 v19, 0xffff0000, v5
    v_lshlrev_b32 v20, 16, v6
    v_and_b32 v21, 0xffff0000, v6
    v_lshlrev_b32 v22, 16, v7
    v_and_b32 v23, 0xffff0000, v7
    v_pk_add_f32 v[4:5], v[16:17], v[18:19]
    v_pk_add_f32 v[6:7], v[20:21], v[22:23]
    v_pk_add_f32 v[4:5], v[4:5], v[6:7]
    v_add_f32 v4, v4, v5
    v_add_f32 v4, v4, v8
    s_nop 1
    v_add_f32_dpp v4, v4, v4 row_ror:8 row_mask:0xf bank_mask:0xf
    s_nop 1
    v_add_f32_dpp v4, v4, v4 row_ror:4 row_mask:0xf bank_mask:0xf
    s_nop 1
    v_add_f32_dpp v4, v4, v4 row_ror:2 row_mask:0xf bank_mask:0xf
    s_nop 1
    v_add_f32_dpp v4, v4, v4 row_ror:1 row_mask:0xf bank_mask:0xf
    v_mov_b32 v5, v4
    s_nop 1
    v_permlane16_swap_b32 v4, v5
    v_add_f32 v4, v4, v5
    v_mov_b32 v5, v4
    s_nop 1
    v_permlane32_swap_b32 v4, v5
    v_add_f32 v4, v4, v5
    v_mul_f32 v4, 0x3ae38e39, v4
    v_pk_add_f32 v[26:27], v[16:17], v[4:5] op_sel_hi:[1,0] neg_lo:[0,1] neg_hi:[0,1]
    v_pk_add_f32 v[28:29], v[18:19], v[4:5] op_sel_hi:[1,0] neg_lo:[0,1] neg_hi:[0,1]
    v_pk_add_f32 v[30:31], v[20:21], v[4:5] op_sel_hi:[1,0] neg_lo:[0,1] neg_hi:[0,1]
    v_pk_add_f32 v[32:33], v[22:23], v[4:5] op_sel_hi:[1,0] neg_lo:[0,1] neg_hi:[0,1]
    v_sub_f32 v9, v8, v4
    v_pk_mul_f32 v[6:7], v[26:27], v[26:27]
    v_pk_fma_f32 v[6:7], v[28:29], v[28:29], v[6:7]
    v_pk_fma_f32 v[6:7], v[30:31], v[30:31], v[6:7]
    v_pk_fma_f32 v[6:7], v[32:33], v[32:33], v[6:7]
    v_fmac_f32 v6, v9, v9
    v_add_f32 v6, v6, v7
    s_nop 1
    v_add_f32_dpp v6, v6, v6 row_ror:8 row_mask:0xf bank_mask:0xf
    s_nop 1
    v_add_f32_dpp v6, v6, v6 row_ror:4 row_mask:0xf bank_mask:0xf
    s_nop 1
    v_add_f32_dpp v6, v6, v6 row_ror:2 row_mask:0xf bank_mask:0xf
    s_nop 1
    v_add_f32_dpp v6, v6, v6 row_ror:1 row_mask:0xf bank_mask:0xf
    v_mov_b32 v7, v6
    s_nop 1
    v_permlane16_swap_b32 v6, v7
    v_add_f32 v6, v6, v7
    v_mov_b32 v7, v6
    s_nop 1
    v_permlane32_swap_b32 v6, v7
    v_add_f32 v6, v6, v7
    v_mul_f32 v6, 0x3ae38e39, v6
    v_cvt_pk_bf16_f32 v5, v4, v6
    v_lshlrev_b32 v4, 16, v5
    v_and_b32 v6, 0xffff0000, v5
    v_add_f32 v6, 0x3727c5ac, v6
    v_cvt_pk_bf16_f32 v6, v6, v6
    v_lshlrev_b32 v6, 16, v6
    v_sqrt_f32 v6, v6
    v_pk_add_f32 v[16:17], v[16:17], v[4:5] op_sel_hi:[1,0] neg_lo:[0,1] neg_hi:[0,1]
    v_pk_add_f32 v[18:19], v[18:19], v[4:5] op_sel_hi:[1,0] neg_lo:[0,1] neg_hi:[0,1]
    v_pk_add_f32 v[20:21], v[20:21], v[4:5] op_sel_hi:[1,0] neg_lo:[0,1] neg_hi:[0,1]
    v_pk_add_f32 v[22:23], v[22:23], v[4:5] op_sel_hi:[1,0] neg_lo:[0,1] neg_hi:[0,1]
    v_sub_f32 v8, v8, v4
    v_cvt_pk_bf16_f32 v6, v6, v6
    v_lshlrev_b32 v6, 16, v6
    v_rcp_f32 v10, v6
    v_cvt_pk_bf16_f32 v5, v16, v17
    v_lshlrev_b32 v16, 16, v5
    v_and_b32 v17, 0xffff0000, v5
    v_cvt_pk_bf16_f32 v5, v18, v19
    v_lshlrev_b32 v18, 16, v5
    v_and_b32 v19, 0xffff0000, v5
    v_cvt_pk_bf16_f32 v5, v20, v21
    v_lshlrev_b32 v20, 16, v5
    v_and_b32 v21, 0xffff0000, v5
    v_cvt_pk_bf16_f32 v5, v22, v23
    v_lshlrev_b32 v22, 16, v5
    v_and_b32 v23, 0xffff0000, v5
    v_fma_f32 v9, -v6, v10, 1.0
    v_cvt_pk_bf16_f32 v8, v8, v8
    v_fmac_f32 v10, v9, v10
    v_lshlrev_b32 v8, 16, v8
    v_pk_mul_f32 v[16:17], v[16:17], v[10:11] op_sel_hi:[1,0]
    v_pk_mul_f32 v[18:19], v[18:19], v[10:11] op_sel_hi:[1,0]
    v_pk_mul_f32 v[20:21], v[20:21], v[10:11] op_sel_hi:[1,0]
    v_pk_mul_f32 v[22:23], v[22:23], v[10:11] op_sel_hi:[1,0]
    v_mul_f32 v8, v8, v10
    s_mul_i32 s61, s3, 2304
    v_lshl_add_u32 v12, v0, 5, s61
    v_lshl_add_u32 v13, v0, 2, s61
    v_cvt_pk_bf16_f32 v16, v16, v16
    v_cvt_pk_bf16_f32 v17, v17, v17
    v_cvt_pk_bf16_f32 v18, v18, v18
    v_cvt_pk_bf16_f32 v19, v19, v19
    v_cvt_pk_bf16_f32 v20, v20, v20
    v_cvt_pk_bf16_f32 v21, v21, v21
    v_cvt_pk_bf16_f32 v22, v22, v22
    v_cvt_pk_bf16_f32 v23, v23, v23
    v_cvt_pk_bf16_f32 v8, v8, v8
    s_cmp_eq_u32 s79, 1
    s_cbranch_scc1 L_ln_again
    ds_write_b128 v12, v[16:19] offset:0
    ds_write_b128 v12, v[20:23] offset:16
    ds_write_b32 v13, v8 offset:2048
    s_waitcnt lgkmcnt(0)
    s_branch L_fa3
L_fa2:
    s_cmp_eq_u32 s3, 2
    s_cbranch_scc1 L_fa4
    s_sub_u32 s64, s83, 384
    v_lshlrev_b32 v4, 7, v0
    s_mov_b64 exec, 15
    buffer_store_dword v23, v4, s[44:47], s64 offen sc1
    s_mov_b64 exec, -1
    s_waitcnt vmcnt(0)
    s_branch L_fa3
L_fa4:
L_fa3:
    s_mov_b32 s61, s65
    v_mov_b32 v23, 0
    s_mov_b64 vcc, 0
    s_mov_b32 s63, 0x3fb8aa3b
    s_barrier
    s_barrier
    s_barrier
    s_branch L_loop
L_drain1:
    s_waitcnt vmcnt(12)
    v_mfma_f32_16x16x32_bf16 v[24:27], v[96:99], v[4:7], 0
    v_mfma_f32_16x16x32_bf16 v[28:31], v[104:107], v[4:7], 0
    v_mfma_f32_16x16x32_bf16 v[24:27], v[100:103], v[8:11], v[24:27]
    v_mfma_f32_16x16x32_bf16 v[28:31], v[108:111], v[8:11], v[28:31]
    s_nop 6
    v_mov_b32_dpp v36, v25 quad_perm:[1,1,3,3] row_mask:0xf bank_mask:0xf
    v_mov_b32_dpp v37, v27 quad_perm:[1,1,3,3] row_mask:0xf bank_mask:0xf
    v_mov_b32_dpp v38, v29 quad_perm:[1,1,3,3] row_mask:0xf bank_mask:0xf
    v_mov_b32_dpp v39, v31 quad_perm:[1,1,3,3] row_mask:0xf bank_mask:0xf
    v_add_f32_dpp v32, v24, v36 quad_perm:[0,0,2,2] row_mask:0xf bank_mask:0xf
    v_add_f32_dpp v33, v26, v37 quad_perm:[0,0,2,2] row_mask:0xf bank_mask:0xf
    v_add_f32_dpp v34, v28, v38 quad_perm:[0,0,2,2] row_mask:0xf bank_mask:0xf
    v_add_f32_dpp v35, v30, v39 quad_perm:[0,0,2,2] row_mask:0xf bank_mask:0xf
    v_cvt_pk_bf16_f32 v36, v32, v33
    v_lshlrev_b32 v32, 16, v36
    v_and_b32 v33, 0xffff0000, v36
    v_cvt_pk_bf16_f32 v37, v34, v35
    v_lshlrev_b32 v34, 16, v37
    v_and_b32 v35, 0xffff0000, v37
    v_mul_f32 v32, 0x3db504f3, v32
    v_mul_f32 v33, 0x3db504f3, v33
    v_mul_f32 v34, 0x3db504f3, v34
    v_mul_f32 v35, 0x3db504f3, v35
    v_cvt_pk_bf16_f32 v36, v32, v33
    v_lshlrev_b32 v32, 16, v36
    v_and_b32 v33, 0xffff0000, v36
    v_cvt_pk_bf16_f32 v37, v34, v35
    v_lshlrev_b32 v34, 16, v37
    v_and_b32 v35, 0xffff0000, v37
    v_max3_f32 v45, v32, v33, v34
    v_max_f32 v45, v45, v35
    v_mov_b32 v46, v45
    s_nop 1
    v_permlane16_swap_b32 v45, v46
    v_max_f32 v45, v45, v46
    v_mov_b32 v46, v45
    s_nop 1
    v_permlane32_swap_b32 v45, v46
    v_max_f32 v45, v45, v46
    v_mul_f32 v45, s63, v45
    v_max_f32 v47, v20, v45
    v_sub_f32 v44, v20, v47
    v_fma_f32 v40, v32, s63, -v47
    v_fma_f32 v41, v33, s63, -v47
    v_fma_f32 v42, v34, s63, -v47
    v_fma_f32 v43, v35, s63, -v47
    v_exp_f32 v44, v44
    v_exp_f32 v40, v40
    v_exp_f32 v41, v41
    v_exp_f32 v42, v42
    v_exp_f32 v43, v43
    v_mov_b32 v20, v47
    v_mul_f32 v16, v16, v44
    v_mul_f32 v17, v17, v44
    v_mul_f32 v18, v18, v44
    v_mul_f32 v19, v19, v44
    v_cvt_pk_bf16_f32 v36, v40, v40
    v_cvt_pk_bf16_f32 v37, v41, v41
    v_cvt_pk_bf16_f32 v38, v42, v42
    v_cvt_pk_bf16_f32 v39, v43, v43
    v_add_f32 v40, v40, v41
    v_add_f32 v42, v42, v43
    v_fma_f32 v21, v21, v44, v40
    v_add_f32 v21, v21, v42
    v_and_b32 v48, v36, v12
    v_and_b32 v49, v36, v13
    v_and_b32 v50, v36, v14
    v_and_b32 v51, v36, v15
    s_waitcnt vmcnt(11)
    s_nop 0
    v_mfma_f32_16x16x32_bf16 v[16:19], v[48:51], v[112:115], v[16:19]
    v_and_b32 v52, v37, v12
    v_and_b32 v53, v37, v13
    v_and_b32 v54, v37, v14
    v_and_b32 v55, v37, v15
    s_waitcnt vmcnt(10)
    s_nop 0
    v_mfma_f32_16x16x32_bf16 v[16:19], v[52:55], v[116:119], v[16:19]
    v_and_b32 v48, v38, v12
    v_and_b32 v49, v38, v13
    v_and_b32 v50, v38, v14
    v_and_b32 v51, v38, v15
    s_waitcnt vmcnt(9)
    s_nop 0
    v_mfma_f32_16x16x32_bf16 v[16:19], v[48:51], v[120:123], v[16:19]
    v_and_b32 v52, v39, v12
    v_and_b32 v53, v39, v13
    v_and_b32 v54, v39, v14
    v_and_b32 v55, v39, v15
    s_waitcnt vmcnt(8)
    s_nop 0
    v_mfma_f32_16x16x32_bf16 v[16:19], v[52:55], v[124:127], v[16:19]
    s_waitcnt vmcnt(4)
    v_mfma_f32_16x16x32_bf16 v[24:27], v[64:67], v[4:7], 0
    v_mfma_f32_16x16x32_bf16 v[28:31], v[72:75], v[4:7], 0
    v_mfma_f32_16x16x32_bf16 v[24:27], v[68:71], v[8:11], v[24:27]
    v_mfma_f32_16x16x32_bf16 v[28:31], v[76:79], v[8:11], v[28:31]
    s_nop 6
    v_mov_b32_dpp v36, v25 quad_perm:[1,1,3,3] row_mask:0xf bank_mask:0xf
    v_mov_b32_dpp v37, v27 quad_perm:[1,1,3,3] row_mask:0xf bank_mask:0xf
    v_mov_b32_dpp v38, v29 quad_perm:[1,1,3,3] row_mask:0xf bank_mask:0xf
    v_mov_b32_dpp v39, v31 quad_perm:[1,1,3,3] row_mask:0xf bank_mask:0xf
    v_add_f32_dpp v32, v24, v36 quad_perm:[0,0,2,2] row_mask:0xf bank_mask:0xf
    v_add_f32_dpp v33, v26, v37 quad_perm:[0,0,2,2] row_mask:0xf bank_mask:0xf
    v_add_f32_dpp v34, v28, v38 quad_perm:[0,0,2,2] row_mask:0xf bank_mask:0xf
    v_add_f32_dpp v35, v30, v39 quad_perm:[0,0,2,2] row_mask:0xf bank_mask:0xf
    v_cvt_pk_bf16_f32 v36, v32, v33
    v_lshlrev_b32 v32, 16, v36
    v_and_b32 v33, 0xffff0000, v36
    v_cvt_pk_bf16_f32 v37, v34, v35
    v_lshlrev_b32 v34, 16, v37
    v_and_b32 v35, 0xffff0000, v37
    v_mul_f32 v32, 0x3db504f3, v32
    v_mul_f32 v33, 0x3db504f3, v33
    v_mul_f32 v34, 0x3db504f3, v34
    v_mul_f32 v35, 0x3db504f3, v35
    v_cvt_pk_bf16_f32 v36, v32, v33
    v_lshlrev_b32 v32, 16, v36
    v_and_b32 v33, 0xffff0000, v36
    v_cvt_pk_bf16_f32 v37, v34, v35
    v_lshlrev_b32 v34, 16, v37
    v_and_b32 v35, 0xffff0000, v37
    v_max3_f32 v45, v32, v33, v34
    v_max_f32 v45, v45, v35
    v_mov_b32 v46, v45
    s_nop 1
    v_permlane16_swap_b32 v45, v46
    v_max_f32 v45, v45, v46
    v_mov_b32 v46, v45
    s_nop 1
    v_permlane32_swap_b32 v45, v46
    v_max_f32 v45, v45, v46
    v_mul_f32 v45, s63, v45
    v_max_f32 v47, v20, v45
    v_sub_f32 v44, v20, v47
    v_fma_f32 v40, v32, s63, -v47
    v_fma_f32 v41, v33, s63, -v47
    v_fma_f32 v42, v34, s63, -v47
    v_fma_f32 v43, v35, s63, -v47
    v_exp_f32 v44, v44
    v_exp_f32 v40, v40
    v_exp_f32 v41, v41
    v_exp_f32 v42, v42
    v_exp_f32 v43, v43
    v_mov_b32 v20, v47
    v_mul_f32 v16, v16, v44
    v_mul_f32 v17, v17, v44
    v_mul_f32 v18, v18, v44
    v_mul_f32 v19, v19, v44
    v_cvt_pk_bf16_f32 v36, v40, v40
    v_cvt_pk_bf16_f32 v37, v41, v41
    v_cvt_pk_bf16_f32 v38, v42, v42
    v_cvt_pk_bf16_f32 v39, v43, v43
    v_add_f32 v40, v40, v41
    v_add_f32 v42, v42, v43
    v_fma_f32 v21, v21, v44, v40
    v_add_f32 v21, v21, v42
    v_mov_b32 v46, v21
    s_nop 1
    v_permlane16_swap_b32 v21, v46
    v_add_f32 v21, v21, v46
    v_mov_b32 v46, v21
    s_nop 1
    v_permlane32_swap_b32 v21, v46
    v_add_f32 v21, v21, v46
    s_cmp_eq_u32 s79, 1
    s_cbranch_scc1 L_dry_85
    ds_write2_b32 v57, v20, v21 offset0:0 offset1:4
L_dry_85:
    v_and_b32 v48, v36, v12
    v_and_b32 v49, v36, v13
    v_and_b32 v50, v36, v14
    v_and_b32 v51, v36, v15
    s_waitcnt vmcnt(3)
    s_nop 0
    v_mfma_f32_16x16x32_bf16 v[16:19], v[48:51], v[80:83], v[16:19]
    v_and_b32 v52, v37, v12
    v_and_b32 v53, v37, v13
    v_and_b32 v54, v37, v14
    v_and_b32 v55, v37, v15
    s_waitcnt vmcnt(2)
    s_nop 0
    v_mfma_f32_16x16x32_bf16 v[16:19], v[52:55], v[84:87], v[16:19]
    v_and_b32 v48, v38, v12
    v_and_b32 v49, v38, v13
    v_and_b32 v50, v38, v14
    v_and_b32 v51, v38, v15
    s_waitcnt vmcnt(1)
    s_nop 0
    v_mfma_f32_16x16x32_bf16 v[16:19], v[48:51], v[88:91], v[16:19]
    v_and_b32 v52, v39, v12
    v_and_b32 v53, v39, v13
    v_and_b32 v54, v39, v14
    v_and_b32 v55, v39, v15
    s_waitcnt vmcnt(0)
    s_nop 0
    v_mfma_f32_16x16x32_bf16 v[16:19], v[52:55], v[92:95], v[16:19]
    s_cmp_eq_u32 s79, 1
    s_cbranch_scc1 L_drain0
    s_branch L_epi2
L_drain0:
    s_waitcnt vmcnt(12)
    v_mfma_f32_16x16x32_bf16 v[24:27], v[64:67], v[4:7], 0
    v_mfma_f32_16x16x32_bf16 v[28:31], v[72:75], v[4:7], 0
    v_mfma_f32_16x16x32_bf16 v[24:27], v[68:71], v[8:11], v[24:27]
    v_mfma_f32_16x16x32_bf16 v[28:31], v[76:79], v[8:11], v[28:31]
    s_nop 6
    v_mov_b32_dpp v36, v25 quad_perm:[1,1,3,3] row_mask:0xf bank_mask:0xf
    v_mov_b32_dpp v37, v27 quad_perm:[1,1,3,3] row_mask:0xf bank_mask:0xf
    v_mov_b32_dpp v38, v29 quad_perm:[1,1,3,3] row_mask:0xf bank_mask:0xf
    v_mov_b32_dpp v39, v31 quad_perm:[1,1,3,3] row_mask:0xf bank_mask:0xf
    v_add_f32_dpp v32, v24, v36 quad_perm:[0,0,2,2] row_mask:0xf bank_mask:0xf
    v_add_f32_dpp v33, v26, v37 quad_perm:[0,0,2,2] row_mask:0xf bank_mask:0xf
    v_add_f32_dpp v34, v28, v38 quad_perm:[0,0,2,2] row_mask:0xf bank_mask:0xf
    v_add_f32_dpp v35, v30, v39 quad_perm:[0,0,2,2] row_mask:0xf bank_mask:0xf
    v_cvt_pk_bf16_f32 v36, v32, v33
    v_lshlrev_b32 v32, 16, v36
    v_and_b32 v33, 0xffff0000, v36
    v_cvt_pk_bf16_f32 v37, v34, v35
    v_lshlrev_b32 v34, 16, v37
    v_and_b32 v35, 0xffff0000, v37
    v_mul_f32 v32, 0x3db504f3, v32
    v_mul_f32 v33, 0x3db504f3, v33
    v_mul_f32 v34, 0x3db504f3, v34
    v_mul_f32 v35, 0x3db504f3, v35
    v_cvt_pk_bf16_f32 v36, v32, v33
    v_lshlrev_b32 v32, 16, v36
    v_and_b32 v33, 0xffff0000, v36
    v_cvt_pk_bf16_f32 v37, v34, v35
    v_lshlrev_b32 v34, 16, v37
    v_and_b32 v35, 0xffff0000, v37
    v_max3_f32 v45, v32, v33, v34
    v_max_f32 v45, v45, v35
    v_mov_b32 v46, v45
    s_nop 1
    v_permlane16_swap_b32 v45, v46
    v_max_f32 v45, v45, v46
    v_mov_b32 v46, v45
    s_nop 1
    v_permlane32_swap_b32 v45, v46
    v_max_f32 v45, v45, v46
    v_mul_f32 v45, s63, v45
    v_max_f32 v47, v20, v45
    v_sub_f32 v44, v20, v47
    v_fma_f32 v40, v32, s63, -v47
    v_fma_f32 v41, v33, s63, -v47
    v_fma_f32 v42, v34, s63, -v47
    v_fma_f32 v43, v35, s63, -v47
    v_exp_f32 v44, v44
    v_exp_f32 v40, v40
    v_exp_f32 v41, v41
    v_exp_f32 v42, v42
    v_exp_f32 v43, v43
    v_mov_b32 v20, v47
    v_mul_f32 v16, v16, v44
    v_mul_f32 v17, v17, v44
    v_mul_f32 v18, v18, v44
    v_mul_f32 v19, v19, v44
    v_cvt_pk_bf16_f32 v36, v40, v40
    v_cvt_pk_bf16_f32 v37, v41, v41
    v_cvt_pk_bf16_f32 v38, v42, v42
    v_cvt_pk_bf16_f32 v39, v43, v43
    v_add_f32 v40, v40, v41
    v_add_f32 v42, v42, v43
    v_fma_f32 v21, v21, v44, v40
    v_add_f32 v21, v21, v42
    v_and_b32 v48, v36, v12
    v_and_b32 v49, v36, v13
    v_and_b32 v50, v36, v14
    v_and_b32 v51, v36, v15
    s_waitcnt vmcnt(11)
    s_nop 0
    v_mfma_f32_16x16x32_bf16 v[16:19], v[48:51], v[80:83], v[16:19]
    v_and_b32 v52, v37, v12
    v_and_b32 v53, v37, v13
    v_and_b32 v54, v37, v14
    v_and_b32 v55, v37, v15
    s_waitcnt vmcnt(10)
    s_nop 0
    v_mfma_f32_16x16x32_bf16 v[16:19], v[52:55], v[84:87], v[16:19]
    v_and_b32 v48, v38, v12
    v_and_b32 v49, v38, v13
    v_and_b32 v50, v38, v14
    v_and_b32 v51, v38, v15
    s_waitcnt vmcnt(9)
    s_nop 0
    v_mfma_f32_16x16x32_bf16 v[16:19], v[48:51], v[88:91], v[16:19]
    v_and_b32 v52, v39, v12
    v_and_b32 v53, v39, v13
    v_and_b32 v54, v39, v14
    v_and_b32 v55, v39, v15
    s_waitcnt vmcnt(8)
    s_nop 0
    v_mfma_f32_16x16x32_bf16 v[16:19], v[52:55], v[92:95], v[16:19]
    s_waitcnt vmcnt(4)
    v_mfma_f32_16x16x32_bf16 v[24:27], v[96:99], v[4:7], 0
    v_mfma_f32_16x16x32_bf16 v[28:31], v[104:107], v[4:7], 0
    v_mfma_f32_16x16x32_bf16 v[24:27], v[100:103], v[8:11], v[24:27]
    v_mfma_f32_16x16x32_bf16 v[28:31], v[108:111], v[8:11], v[28:31]
    s_nop 6
    v_mov_b32_dpp v36, v25 quad_perm:[1,1,3,3] row_mask:0xf bank_mask:0xf
    v_mov_b32_dpp v37, v27 quad_perm:[1,1,3,3] row_mask:0xf bank_mask:0xf
    v_mov_b32_dpp v38, v29 quad_perm:[1,1,3,3] row_mask:0xf bank_mask:0xf
    v_mov_b32_dpp v39, v31 quad_perm:[1,1,3,3] row_mask:0xf bank_mask:0xf
    v_add_f32_dpp v32, v24, v36 quad_perm:[0,0,2,2] row_mask:0xf bank_mask:0xf
    v_add_f32_dpp v33, v26, v37 quad_perm:[0,0,2,2] row_mask:0xf bank_mask:0xf
    v_add_f32_dpp v34, v28, v38 quad_perm:[0,0,2,2] row_mask:0xf bank_mask:0xf
    v_add_f32_dpp v35, v30, v39 quad_perm:[0,0,2,2] row_mask:0xf bank_mask:0xf
    v_cvt_pk_bf16_f32 v36, v32, v33
    v_lshlrev_b32 v32, 16, v36
    v_and_b32 v33, 0xffff0000, v36
    v_cvt_pk_bf16_f32 v37, v34, v35
    v_lshlrev_b32 v34, 16, v37
    v_and_b32 v35, 0xffff0000, v37
    v_mul_f32 v32, 0x3db504f3, v32
    v_mul_f32 v33, 0x3db504f3, v33
    v_mul_f32 v34, 0x3db504f3, v34
    v_mul_f32 v35, 0x3db504f3, v35
    v_cvt_pk_bf16_f32 v36, v32, v33
    v_lshlrev_b32 v32, 16, v36
    v_and_b32 v33, 0xffff0000, v36
    v_cvt_pk_bf16_f32 v37, v34, v35
    v_lshlrev_b32 v34, 16, v37
    v_and_b32 v35, 0xffff0000, v37
    v_max3_f32 v45, v32, v33, v34
    v_max_f32 v45, v45, v35
    v_mov_b32 v46, v45
    s_nop 1
    v_permlane16_swap_b32 v45, v46
    v_max_f32 v45, v45, v46
    v_mov_b32 v46, v45
    s_nop 1
    v_permlane32_swap_b32 v45, v46
    v_max_f32 v45, v45, v46
    v_mul_f32 v45, s63, v45
    v_max_f32 v47, v20, v45
    v_sub_f32 v44, v20, v47
    v_fma_f32 v40, v32, s63, -v47
    v_fma_f32 v41, v33, s63, -v47
    v_fma_f32 v42, v34, s63, -v47
    v_fma_f32 v43, v35, s63, -v47
    v_exp_f32 v44, v44
    v_exp_f32 v40, v40
    v_exp_f32 v41, v41
    v_exp_f32 v42, v42
    v_exp_f32 v43, v43
    v_mov_b32 v20, v47
    v_mul_f32 v16, v16, v44
    v_mul_f32 v17, v17, v44
    v_mul_f32 v18, v18, v44
    v_mul_f32 v19, v19, v44
    v_cvt_pk_bf16_f32 v36, v40, v40
    v_cvt_pk_bf16_f32 v37, v41, v41
    v_cvt_pk_bf16_f32 v38, v42, v42
    v_cvt_pk_bf16_f32 v39, v43, v43
    v_add_f32 v40, v40, v41
    v_add_f32 v42, v42, v43
    v_fma_f32 v21, v21, v44, v40
    v_add_f32 v21, v21, v42
    v_mov_b32 v46, v21
    s_nop 1
    v_permlane16_swap_b32 v21, v46
    v_add_f32 v21, v21, v46
    v_mov_b32 v46, v21
    s_nop 1
    v_permlane32_swap_b32 v21, v46
    v_add_f32 v21, v21, v46
    s_cmp_eq_u32 s79, 1
    s_cbranch_scc1 L_dry_86
    ds_write2_b32 v57, v20, v21 offset0:0 offset1:4
L_dry_86:
    v_and_b32 v48, v36, v12
    v_and_b32 v49, v36, v13
    v_and_b32 v50, v36, v14
    v_and_b32 v51, v36, v15
    s_waitcnt vmcnt(3)
    s_nop 0
    v_mfma_f32_16x16x32_bf16 v[16:19], v[48:51], v[112:115], v[16:19]
    v_and_b32 v52, v37, v12
    v_and_b32 v53, v37, v13
    v_and_b32 v54, v37, v14
    v_and_b32 v55, v37, v15
    s_waitcnt vmcnt(2)
    s_nop 0
    v_mfma_f32_16x16x32_bf16 v[16:19], v[52:55], v[116:119], v[16:19]
    v_and_b32 v48, v38, v12
    v_and_b32 v49, v38, v13
    v_and_b32 v50, v38, v14
    v_and_b32 v51, v38, v15
    s_waitcnt vmcnt(1)
    s_nop 0
    v_mfma_f32_16x16x32_bf16 v[16:19], v[48:51], v[120:123], v[16:19]
    v_and_b32 v52, v39, v12
    v_and_b32 v53, v39, v13
    v_and_b32 v54, v39, v14
    v_and_b32 v55, v39, v15
    s_waitcnt vmcnt(0)
    s_nop 0
    v_mfma_f32_16x16x32_bf16 v[16:19], v[52:55], v[124:127], v[16:19]
    s_cmp_eq_u32 s79, 1
    s_cbranch_scc1 L_ddry_ret
L_epi2:
    s_nop 5
    ds_write_b128 v56, v[16:19]
L_epi3:
    v_mov_b32 v61, 1
    s_mov_b64 exec, 1
    ds_add_rtn_u32 v61, v23, v61 offset:8992
    s_mov_b64 exec, -1
L_pub:
    ds_read_b128 v[128:131], v23 offset:8960
    ds_read_b128 v[132:135], v23 offset:8976
    ds_read_b64 v[136:137], v58 offset:6912
    ds_read_b64 v[138:139], v58 offset:7424
    ds_read_b64 v[140:141], v58 offset:7936
    ds_read_b64 v[142:143], v58 offset:8448
    s_cmp_eq_u32 s79, 1
    s_cbranch_scc1 L_dry_87
    s_waitcnt lgkmcnt(6)
    v_readfirstlane_b32 s64, v61
    s_nop 0
    s_cmp_lg_u32 s64, 3
    s_cbranch_scc1 L_nopub
L_dry_87:
    v_mov_b32 v147, s73
    s_waitcnt lgkmcnt(4)
    v_max3_f32 v148, v128, v129, v130
    v_max_f32 v148, v148, v131
    v_sub_f32 v128, v128, v148
    v_sub_f32 v129, v129, v148
    v_sub_f32 v130, v130, v148
    v_sub_f32 v131, v131, v148
    v_exp_f32 v128, v128
    v_exp_f32 v129, v129
    v_exp_f32 v130, v130
    v_exp_f32 v131, v131
    s_nop 0
    v_mul_f32 v149, v128, v132
    v_fmac_f32 v149, v129, v133
    v_fmac_f32 v149, v130, v134
    v_fmac_f32 v149, v131, v135
    v_rcp_f32 v150, v149
    v_log_f32 v149, v149
    s_waitcnt lgkmcnt(0)
    v_pk_mul_f32 v[144:145], v[136:137], v[128:129] op_sel_hi:[1,0]
    v_pk_fma_f32 v[144:145], v[138:139], v[128:129], v[144:145] op_sel:[0,1,0] op_sel_hi:[1,1,1]
    v_pk_fma_f32 v[144:145], v[140:141], v[130:131], v[144:145] op_sel_hi:[1,0,1]
    v_pk_fma_f32 v[144:145], v[142:143], v[130:131], v[144:145] op_sel:[0,1,0] op_sel_hi:[1,1,1]
    v_add_f32 v146, v149, v148
    v_pk_mul_f32 v[144:145], v[144:145], v[150:151] op_sel_hi:[1,0]
    v_cvt_pk_bf16_f32 v144, v144, v145
    s_nop 1
    v_mov_b32_dpp v145, v144 quad_perm:[1,1,3,3] row_mask:0xf bank_mask:0xf
    s_mov_b32 exec_lo, 0x55555555
    s_mov_b32 exec_hi, 0x55555555
    s_cmp_eq_u32 s79, 1
    s_cbranch_scc1 L_pdry_ret
    buffer_store_dwordx4 v[144:147], v58, s[44:47], s49 offen sc1
    s_mov_b64 exec, -1
L_nopub:
    s_cmp_lg_u32 s3, 0
    s_cbranch_scc1 L_attn_exit
    s_lshr_b32 s64, s59, 2
    s_lshl2_add_u32 s65, s64, s58
    s_cmp_eq_u32 s65, 2
    s_cselect_b32 s65, 8, 72
    s_cmp_eq_u32 s58, 1
    s_cselect_b32 s65, s64, s65
    s_mul_i32 s64, s60, 9
    s_add_u32 s65, s65, s64
    s_cmp_ge_u32 s65, 72
    s_cbranch_scc1 L_attn_exit
L_reducer:
    s_mov_b32 s52, s22
    s_mov_b32 s53, s23
    s_mov_b32 s54, 2304
    s_mov_b32 s55, 0x20000
    s_mov_b32 s12, 0x7060500
    s_mov_b32 s13, 0x7060501
    s_mov_b32 s14, 0x7060502
    s_mov_b32 s15, 0x7060503
    s_mov_b32 s16, 0x0c0c0400
    s_mov_b32 s17, 0x04000c0c
    s_lshl_b32 s66, s65, 11
    s_add_u32 s67, s66, 327680
    v_lshlrev_b32 v1, 4, v0
    v_and_b32 v3, 3, v0
    v_lshrrev_b32 v4, 4, v0
    v_lshl_add_u32 v3, v3, 2, v4
    v_lshlrev_b32 v3, 1, v3
    s_lshl_b32 s68, s65, 5
    s_mov_b32 s70, 2097152
    v_mov_b32 v84, 0
    s_mov_b64 s[50:51], -1
    s_mov_b64 s[18:19], -1
    s_cmp_eq_u32 s79, 1
    s_cbranch_scc1 L_rdry1
    s_mov_b32 s28, s4
    s_mov_b32 s29, s5
    s_mov_b32 s30, 2304
    s_mov_b32 s31, 0x20000
    buffer_load_short_d16_hi v84, v3, s[28:31], s68 offen
L_rpoll:
    s_mov_b64 exec, s[50:51]
    buffer_load_dwordx4 v[72:75], v1, s[44:47], s67 offen offset:0 sc1
    buffer_load_dwordx4 v[76:79], v1, s[44:47], s67 offen offset:1024 sc1
    s_mov_b64 exec, s[18:19]
    s_cbranch_execz L_rnoy
    buffer_load_dwordx4 v[64:67], v1, s[44:47], s66 offen offset:0 sc1
    buffer_load_dwordx4 v[68:71], v1, s[44:47], s66 offen offset:1024 sc1
L_rnoy:
    s_mov_b64 exec, -1
L_rdry1:
    s_waitcnt vmcnt(0)
    v_perm_b32 v6, v73, v72, s16
    v_perm_b32 v7, v75, v74, s17
    v_or_b32 v6, v6, v7
    v_xor_b32 v5, s73, v6
    v_perm_b32 v6, v77, v76, s16
    v_perm_b32 v7, v79, v78, s17
    v_or_b32 v6, v6, v7
    v_xor_b32 v6, s73, v6
    v_or_b32 v5, v5, v6
    v_perm_b32 v6, v65, v64, s16
    v_perm_b32 v7, v67, v66, s17
    v_or_b32 v6, v6, v7
    v_xor_b32 v8, s73, v6
    v_perm_b32 v6, v69, v68, s16
    v_perm_b32 v7, v71, v70, s17
    v_or_b32 v6, v6, v7
    v_xor_b32 v6, s73, v6
    v_or_b32 v8, v8, v6
    v_cmp_ne_u32 s[50:51], 0, v5
    v_cmp_ne_u32 s[18:19], 0, v8
    s_cmp_eq_u32 s79, 1
    s_cbranch_scc1 L_rg
    s_sub_u32 s70, s70, 1
    s_cselect_b64 s[50:51], 0, s[50:51]
    s_cselect_b64 s[18:19], 0, s[18:19]
    s_cmp_lg_u64 s[50:51], 0
    s_cbranch_scc1 L_rpoll
    s_mov_b64 exec, s[18:19]
    s_cbranch_execz L_rg0
    buffer_load_dwordx4 v[64:67], v1, s[44:47], s66 offen offset:0 sc1
    buffer_load_dwordx4 v[68:71], v1, s[44:47], s66 offen offset:1024 sc1
L_rg0:
    s_mov_b64 exec, -1
L_rg:
    v_pk_add_f32 v[72:73], v[72:73], v[76:77]
    v_pk_add_f32 v[74:75], v[74:75], v[78:79]
    s_nop 1
    v_permlane32_swap_b32 v72, v74
    v_permlane32_swap_b32 v73, v75
    v_pk_add_f32 v[72:73], v[72:73], v[74:75]
    s_nop 1
    v_permlane16_swap_b32 v72, v73
    v_add_f32 v72, v72, v73
    s_nop 1
    v_add_f32_dpp v72, v72, v72 row_ror:4 row_mask:0xf bank_mask:0xf
    s_nop 1
    v_add_f32_dpp v72, v72, v72 row_ror:8 row_mask:0xf bank_mask:0xf
    v_cvt_pk_bf16_f32 v72, v72, v72
    v_lshlrev_b32 v72, 16, v72
    v_mul_f32 v80, 0xbfb8aa3b, v72
    v_exp_f32 v80, v80
    s_nop 0
    v_add_f32 v80, 1.0, v80
    v_rcp_f32 v80, v80
    s_nop 0
    v_mul_f32 v85, v72, v80
    v_cvt_pk_bf16_f32 v85, v85, v85
    v_lshlrev_b32 v85, 16, v85
    s_cmp_eq_u64 s[18:19], 0
    s_cbranch_scc1 L_rdone
    s_mov_b64 exec, s[18:19]
L_rwait:
    s_waitcnt vmcnt(0)
    v_perm_b32 v6, v65, v64, s16
    v_perm_b32 v7, v67, v66, s17
    v_or_b32 v6, v6, v7
    v_xor_b32 v5, s73, v6
    v_perm_b32 v6, v69, v68, s16
    v_perm_b32 v7, v71, v70, s17
    v_or_b32 v6, v6, v7
    v_xor_b32 v6, s73, v6
    v_or_b32 v5, v5, v6
    v_cmp_ne_u32 vcc, 0, v5
    s_cmp_eq_u32 s79, 1
    s_cbranch_scc1 L_rdone
    s_and_b64 exec, exec, vcc
    s_cbranch_execz L_rdone
    s_sub_u32 s70, s70, 1
    s_cbranch_scc1 L_rdone
    buffer_load_dwordx4 v[64:67], v1, s[44:47], s66 offen offset:0 sc1
    buffer_load_dwordx4 v[68:71], v1, s[44:47], s66 offen offset:1024 sc1
    s_branch L_rwait
L_rdone:
    s_mov_b64 exec, -1
    v_pk_add_f32 v[64:65], v[64:65], v[68:69]
    v_pk_add_f32 v[66:67], v[66:67], v[70:71]
    s_nop 1
    v_permlane32_swap_b32 v64, v66
    v_permlane32_swap_b32 v65, v67
    v_pk_add_f32 v[64:65], v[64:65], v[66:67]
    s_nop 1
    v_permlane16_swap_b32 v64, v65
    v_add_f32 v64, v64, v65
    s_nop 1
    v_add_f32_dpp v64, v64, v64 row_ror:4 row_mask:0xf bank_mask:0xf
    s_nop 1
    v_add_f32_dpp v64, v64, v64 row_ror:8 row_mask:0xf bank_mask:0xf
    v_cvt_pk_bf16_f32 v64, v64, v64
    v_lshlrev_b32 v64, 16, v64
L_rfin:
    v_mul_f32 v64, v64, v85
    v_cvt_pk_bf16_f32 v64, v64, v64
    v_lshlrev_b32 v64, 16, v64
    v_add_f32 v64, v64, v84
    v_cvt_pk_bf16_f32 v64, v64, v64
    s_cmp_eq_u32 s79, 1
    s_cbranch_scc1 L_rdry_ret
    s_mov_b32 exec_lo, 0x000f000f
    s_mov_b32 exec_hi, 0x000f000f
    buffer_store_short v64, v3, s[52:55], s68 offen
    s_cmp_lg_u32 s65, 0
    s_cbranch_scc1 L_attn_exit
    v_mov_b32 v5, s73
    v_mov_b32 v6, 626820
    s_mov_b64 exec, 1
    buffer_store_dword v5, v6, s[44:47], 0 offen sc1
L_attn_exit:
    s_endpgm
L_aux:
    s_waitcnt lgkmcnt(0)
    s_load_dword s78, s[26:27], 626820
    s_mov_b32 s28, s4
    s_mov_b32 s29, s5
    s_mov_b32 s30, 2304
    s_mov_b32 s31, 0x20000
    s_mov_b32 s36, s12
    s_mov_b32 s37, s13
    s_mov_b32 s38, 4718592
    s_mov_b32 s39, 0x20000
    s_mov_b32 s40, s20
    s_mov_b32 s41, s21
    s_mov_b32 s42, 5308416
    s_mov_b32 s43, 0x20000
    s_mov_b32 s44, s26
    s_mov_b32 s45, s27
    s_mov_b32 s46, 758016
    s_mov_b32 s47, 0x20000
    s_mov_b32 s4, s16
    s_mov_b32 s5, s17
    s_mov_b32 s6, 5308416
    s_mov_b32 s7, 0x20000
    s_mov_b32 s8, s18
    s_mov_b32 s9, s19
    s_mov_b32 s10, 5308416
    s_mov_b32 s11, 0x20000
    s_mov_b32 s12, 0x7060500
    s_mov_b32 s13, 0x7060501
    s_mov_b32 s14, 0x7060502
    s_mov_b32 s15, 0x7060503
    s_mov_b32 s16, 0x0c0c0400
    s_mov_b32 s17, 0x04000c0c
    v_and_b32 v14, 1, v0
    v_lshlrev_b32 v14, 4, v14
    v_mov_b32 v15, 0xffff
    v_lshlrev_b32 v14, v14, v15
    v_bfe_u32 v15, v0, 1, 2
    v_cmp_eq_u32 s[76:77], 0, v15
    s_nop 1
    v_cndmask_b32 v36, 0, v14, s[76:77]
    v_cmp_eq_u32 s[76:77], 1, v15
    s_nop 1
    v_cndmask_b32 v37, 0, v14, s[76:77]
    v_cmp_eq_u32 s[76:77], 2, v15
    s_nop 1
    v_cndmask_b32 v38, 0, v14, s[76:77]
    v_cmp_eq_u32 s[76:77], 3, v15
    s_nop 1
    v_cndmask_b32 v39, 0, v14, s[76:77]
    v_lshlrev_b32 v15, 5, v1
    v_and_b32 v92, 1, v2
    v_lshl_add_u32 v92, v92, 4, v15
    v_mov_b32 v111, 0
    v_mov_b32 v14, 0
    v_mov_b32 v15, 0
    ds_write_b64 v111, v[14:15] offset:8992
    ds_write_b64 v111, v[14:15] offset:9000
    s_waitcnt lgkmcnt(0)
    s_add_u32 s78, s78, 0x9e3779b1
    s_cmp_eq_u32 s58, 0
    s_cbranch_scc1 L_ffn
    s_barrier
    s_cmp_lg_u32 s3, 0
    s_cbranch_scc1 L_qd_88
    s_lshl1_add_u32 s61, s56, s57
    s_lshl_b32 s61, s61, 9
    s_add_u32 s61, s61, 593920
    v_lshlrev_b32 v32, 3, v0
    v_lshlrev_b32 v33, 2, v0
    s_mov_b32 s70, 2097152
L_qp_89:
    buffer_load_dwordx2 v[34:35], v32, s[44:47], s61 offen sc1
    s_waitcnt vmcnt(0)
    v_cmp_ne_u32 vcc, s78, v35
    s_nop 4
    s_cbranch_vccz L_qo_90
    s_sub_u32 s70, s70, 1
    s_cmp_lg_u32 s70, 0
    s_cbranch_scc1 L_qp_89
L_qo_90:
    ds_write_b32 v33, v34 offset:6656
L_qd_88:
    s_waitcnt lgkmcnt(0)
    s_barrier
L_ffn_ret:
    s_lshr_b32 s64, s59, 2
    s_lshl2_add_u32 s65, s64, s58
    s_cmp_eq_u32 s65, 2
    s_cselect_b32 s65, 8, 72
    s_cmp_eq_u32 s58, 1
    s_cselect_b32 s65, s64, s65
    s_mul_i32 s64, s60, 9
    s_add_u32 s65, s65, s64
    s_cmp_lg_u32 s3, 0
    s_cbranch_scc1 L_nodry4
    s_mov_b32 s79, 1
    s_branch L_drain1
L_ddry_ret:
    s_mov_b32 s79, 0
    v_and_b32 v14, 1, v0
    v_lshlrev_b32 v14, 4, v14
    v_mov_b32 v15, 0xffff
    v_lshlrev_b32 v14, v14, v15
    v_bfe_u32 v15, v0, 1, 2
    v_cmp_eq_u32 s[76:77], 0, v15
    s_nop 1
    v_cndmask_b32 v36, 0, v14, s[76:77]
    v_cmp_eq_u32 s[76:77], 1, v15
    s_nop 1
    v_cndmask_b32 v37, 0, v14, s[76:77]
    v_cmp_eq_u32 s[76:77], 2, v15
    s_nop 1
    v_cndmask_b32 v38, 0, v14, s[76:77]
    v_cmp_eq_u32 s[76:77], 3, v15
    s_nop 1
    v_cndmask_b32 v39, 0, v14, s[76:77]
L_nodry4:
    s_cmp_lg_u32 s3, 2
    s_cbranch_scc1 L_nodry6
    s_mov_b32 s79, 1
    s_cmp_ge_u32 s65, 72
    s_cbranch_scc1 L_pub
    s_branch L_reducer
L_rdry_ret:
    s_branch L_pub
L_pdry_ret:
    s_mov_b64 exec, -1
    s_mov_b32 s79, 0
    v_and_b32 v1, 15, v0
    v_lshrrev_b32 v2, 4, v0
    v_lshlrev_b32 v3, 4, v1
L_nodry6:
    s_cmp_lg_u32 s3, 3
    s_cbranch_scc1 L_nodry7
    s_mov_b32 s79, 1
    s_branch L_tail
L_tdry_ret:
    s_mov_b64 exec, -1
    s_mov_b32 s79, 0
L_nodry7:
    s_barrier
    s_cmp_lg_u32 s3, 1
    s_cbranch_scc1 L_nog
    s_lshr_b32 s61, s59, 3
    s_lshl2_add_u32 s61, s60, s61
    s_mul_i32 s67, s61, 1152
    s_add_u32 s67, s67, 524288
    v_lshlrev_b32 v12, 4, v0
    s_mov_b32 s70, 2097152
    v_add_u32 v13, 0, v0
    v_mul_u32_u24 v14, 0xe39, v13
    v_lshrrev_b32 v14, 16, v14
    v_mul_u32_u24 v15, 18, v14
    v_sub_u32 v13, v13, v15
    v_and_b32 v15, 1, v14
    v_mul_u32_u24 v15, 576, v15
    v_lshrrev_b32 v14, 1, v14
    v_mul_u32_u24 v14, 288, v14
    v_lshl_add_u32 v13, v13, 4, v14
    v_add_u32 v16, v13, v15
    v_add_u32 v13, 64, v0
    v_mul_u32_u24 v14, 0xe39, v13
    v_lshrrev_b32 v14, 16, v14
    v_mul_u32_u24 v15, 18, v14
    v_sub_u32 v13, v13, v15
    v_and_b32 v15, 1, v14
    v_mul_u32_u24 v15, 576, v15
    v_lshrrev_b32 v14, 1, v14
    v_mul_u32_u24 v14, 288, v14
    v_lshl_add_u32 v13, v13, 4, v14
    v_add_u32 v17, v13, v15
L_gpoll:
    buffer_load_dwordx4 v[40:43], v12, s[44:47], s67 offen sc1
    s_mov_b64 exec, 0xff
    buffer_load_dwordx4 v[44:47], v12, s[44:47], s67 offen offset:1024 sc1
    s_waitcnt vmcnt(0)
    v_cmp_ne_u32 s[76:77], s78, v46
    s_mov_b64 exec, -1
    v_cmp_ne_u32 vcc, s78, v42
    s_nop 1
    s_or_b64 vcc, vcc, s[76:77]
    s_cbranch_vccz L_gdone
    s_sub_u32 s70, s70, 1
    s_cmp_lg_u32 s70, 0
    s_cbranch_scc1 L_gpoll
L_gdone:
    s_mov_b32 s61, 0x01000100
    s_mov_b32 s62, 0x03020302
    v_perm_b32 v43, v41, v41, s62
    v_perm_b32 v42, v41, v41, s61
    v_perm_b32 v41, v40, v40, s62
    v_perm_b32 v40, v40, v40, s61
    v_perm_b32 v47, v45, v45, s62
    v_perm_b32 v46, v45, v45, s61
    v_perm_b32 v45, v44, v44, s62
    v_perm_b32 v44, v44, v44, s61
    ds_write_b128 v16, v[40:43] offset:9216
    s_mov_b64 exec, 0xff
    ds_write_b128 v17, v[44:47] offset:9216
    s_mov_b64 exec, -1
L_nog:
L_tail:
    v_mov_b32 v4, 0x40000000
    v_mul_u32_u24 v110, 9216, v2
    v_add_u32 v110, v110, v3
    s_lshr_b32 s75, s59, 3
    s_lshl2_add_u32 s75, s60, s75
    s_and_b32 s74, s60, 6
    s_add_u32 s74, s74, s59
    s_and_b32 s74, s74, 7
    s_cmp_eq_u32 s74, 7
    s_cselect_b32 s64, 16, 8
    v_cmp_gt_u32 vcc, s64, v1
    s_lshl2_add_u32 s61, s75, s3
    s_mul_i32 s72, s61, 36864
    v_cndmask_b32 v93, v4, v110, vcc
    s_lshl_b32 s71, s74, 6
    s_lshl1_add_u32 s72, s71, s72
    s_add_u32 s73, s72, 4608
    s_add_u32 s61, s71, 64
    s_cmp_eq_u32 s74, 0
    s_cselect_b32 s74, 0, s61
    s_cselect_b32 s61, 16, 8
    v_cmp_gt_u32 vcc, s61, v1
    s_mov_b32 s48, s61
    s_nop 0
    v_cndmask_b32 v110, v4, v110, vcc
    v_lshrrev_b32 v5, 3, v1
    v_lshlrev_b32 v94, 11, v5
    v_lshl_add_u32 v94, v2, 5, v94
    v_and_b32 v5, 3, v1
    v_lshl_add_u32 v94, v5, 9, v94
    v_and_b32 v5, 4, v1
    v_lshl_add_u32 v94, v5, 2, v94
    s_lshl_b32 s66, s75, 12
    s_lshl_b32 s61, s3, 7
    s_add_u32 s66, s66, s61
    s_add_u32 s67, s66, 626944
    s_add_u32 s66, s66, 196608
    v_lshlrev_b32 v104, 4, v0
    s_lshl_b32 s61, s3, 10
    v_add_u32 v105, s61, v104
    v_mul_u32_u24 v95, 1152, v2
    v_add_u32 v95, 36864, v95
    v_add_u32 v95, v95, v3
    v_cndmask_b32 v95, v4, v95, vcc
    v_lshrrev_b32 v5, 3, v1
    v_mul_u32_u24 v5, 576, v5
    s_mul_i32 s61, s3, 144
    v_add_u32 v5, s61, v5
    v_lshl_add_u32 v108, v2, 5, v5
    v_lshl_add_u32 v109, v2, 2, v5
    s_lshl2_add_u32 s61, s75, s3
    s_mul_i32 s62, s61, 41472
    s_lshl1_add_u32 s62, s74, s62
    s_add_u32 s63, s62, 4608
    v_cmp_gt_u32 vcc, s64, v1
    v_lshrrev_b32 v5, 2, v92
    v_add_u32 v5, s71, v5
    v_lshrrev_b32 v6, 1, v2
    v_mul_u32_u24 v6, 36, v6
    v_lshrrev_b32 v7, 4, v5
    v_add_u32 v6, v6, v7
    v_lshlrev_b32 v6, 11, v6
    v_and_b32 v5, 15, v5
    v_lshl_add_u32 v6, v5, 2, v6
    v_cndmask_b32 v106, v4, v6, vcc
    v_cmp_gt_u32 vcc, s48, v1
    v_lshrrev_b32 v5, 2, v92
    v_add_u32 v5, s74, v5
    v_lshrrev_b32 v6, 1, v2
    v_mul_u32_u24 v6, 36, v6
    v_lshrrev_b32 v7, 4, v5
    v_add_u32 v6, v6, v7
    v_lshlrev_b32 v6, 11, v6
    v_and_b32 v5, 15, v5
    v_lshl_add_u32 v6, v5, 2, v6
    v_cndmask_b32 v91, v4, v6, vcc
    v_mov_b32 v107, s78
    v_mov_b32 v111, 0
    s_lshl_b32 s68, s75, 6
    s_add_u32 s48, s68, 327680
    s_mov_b32 s70, 2097152
    s_waitcnt lgkmcnt(0)
    s_cmp_eq_u32 s79, 1
    s_cbranch_scc1 L_tdry0
    s_barrier
    buffer_load_dwordx4 v[112:115], v93, s[36:39], s72 offen offset:0 nt
    buffer_load_dwordx4 v[116:119], v93, s[36:39], s72 offen offset:1152 nt
    buffer_load_dwordx4 v[120:123], v93, s[36:39], s72 offen offset:2304 nt
    buffer_load_dwordx4 v[124:127], v93, s[36:39], s72 offen offset:3456 nt
    buffer_load_dwordx4 v[128:131], v93, s[36:39], s73 offen offset:0 nt
    buffer_load_dwordx4 v[132:135], v93, s[36:39], s73 offen offset:1152 nt
    buffer_load_dwordx4 v[136:139], v93, s[36:39], s73 offen offset:2304 nt
    buffer_load_dwordx4 v[140:143], v93, s[36:39], s73 offen offset:3456 nt
    buffer_load_dwordx4 v[144:147], v110, s[40:43], s62 offen offset:0 nt
    buffer_load_dwordx4 v[148:151], v110, s[40:43], s62 offen offset:1152 nt
    buffer_load_dwordx4 v[152:155], v110, s[40:43], s62 offen offset:2304 nt
    buffer_load_dwordx4 v[156:159], v110, s[40:43], s62 offen offset:3456 nt
    buffer_load_dwordx4 v[160:163], v110, s[40:43], s63 offen offset:0 nt
    buffer_load_dwordx4 v[164:167], v110, s[40:43], s63 offen offset:1152 nt
    buffer_load_dwordx4 v[168:171], v110, s[40:43], s63 offen offset:2304 nt
    buffer_load_dwordx4 v[172:175], v110, s[40:43], s63 offen offset:3456 nt
    buffer_load_dwordx4 v[176:179], v95, s[40:43], s62 offen nt
L_tdry0:
    ds_read_b128 v[76:79], v108 offset:9216
    ds_read_b128 v[80:83], v108 offset:9232
    ds_read_b32 v5, v109 offset:9344
    s_waitcnt lgkmcnt(0)
    v_and_b32 v180, v76, v36
    v_and_b32 v181, v76, v37
    v_and_b32 v182, v76, v38
    v_and_b32 v183, v76, v39
    v_and_b32 v184, v77, v36
    v_and_b32 v185, v77, v37
    v_and_b32 v186, v77, v38
    v_and_b32 v187, v77, v39
    v_and_b32 v188, v78, v36
    v_and_b32 v189, v78, v37
    v_and_b32 v190, v78, v38
    v_and_b32 v191, v78, v39
    v_and_b32 v192, v79, v36
    v_and_b32 v193, v79, v37
    v_and_b32 v194, v79, v38
    v_and_b32 v195, v79, v39
    v_and_b32 v196, v80, v36
    v_and_b32 v197, v80, v37
    v_and_b32 v198, v80, v38
    v_and_b32 v199, v80, v39
    v_and_b32 v200, v81, v36
    v_and_b32 v201, v81, v37
    v_and_b32 v202, v81, v38
    v_and_b32 v203, v81, v39
    v_and_b32 v204, v82, v36
    v_and_b32 v205, v82, v37
    v_and_b32 v206, v82, v38
    v_and_b32 v207, v82, v39
    v_and_b32 v208, v83, v36
    v_and_b32 v209, v83, v37
    v_and_b32 v210, v83, v38
    v_and_b32 v211, v83, v39
    v_and_b32 v212, v5, v36
    v_and_b32 v213, v5, v37
    v_and_b32 v214, v5, v38
    v_and_b32 v215, v5, v39
    s_cmp_eq_u32 s79, 1
    s_cbranch_scc1 L_yf
    s_waitcnt vmcnt(0)
    buffer_load_dwordx4 v[40:43], v94, s[44:47], s66 offen sc1
L_yf:
    v_mfma_f32_16x16x32_bf16 v[56:59], v[180:183], v[144:147], 0
    v_mfma_f32_16x16x32_bf16 v[56:59], v[184:187], v[148:151], v[56:59]
    v_mfma_f32_16x16x32_bf16 v[56:59], v[188:191], v[152:155], v[56:59]
    v_mfma_f32_16x16x32_bf16 v[56:59], v[192:195], v[156:159], v[56:59]
    v_mfma_f32_16x16x32_bf16 v[56:59], v[196:199], v[160:163], v[56:59]
    v_mfma_f32_16x16x32_bf16 v[56:59], v[200:203], v[164:167], v[56:59]
    v_mfma_f32_16x16x32_bf16 v[56:59], v[204:207], v[168:171], v[56:59]
    v_mfma_f32_16x16x32_bf16 v[56:59], v[208:211], v[172:175], v[56:59]
    v_mfma_f32_16x16x32_bf16 v[56:59], v[212:215], v[176:179], v[56:59]
    s_nop 5
    s_cmp_eq_u32 s79, 1
    s_cbranch_scc1 L_md_91
    ds_write_b128 v105, v[56:59] offset:14464
    v_mov_b32 v5, 1
    s_mov_b64 exec, 1
    ds_add_rtn_u32 v5, v111, v5 offset:9000
    s_mov_b64 exec, -1
L_md_91:
    ds_read_b128 v[60:63], v104 offset:14464
    ds_read_b128 v[64:67], v104 offset:15488
    ds_read_b128 v[68:71], v104 offset:16512
    ds_read_b128 v[72:75], v104 offset:17536
    s_cmp_eq_u32 s79, 1
    s_cbranch_scc1 L_dry_92
    s_waitcnt lgkmcnt(4)
    v_readfirstlane_b32 s64, v5
    s_nop 0
    s_cmp_lg_u32 s64, 3
    s_cbranch_scc1 L_yfd
L_dry_92:
    s_waitcnt lgkmcnt(2)
    v_pk_add_f32 v[60:61], v[60:61], v[64:65]
    v_pk_add_f32 v[62:63], v[62:63], v[66:67]
    s_waitcnt lgkmcnt(0)
    v_pk_add_f32 v[68:69], v[68:69], v[72:73]
    v_pk_add_f32 v[70:71], v[70:71], v[74:75]
    v_pk_add_f32 v[60:61], v[60:61], v[68:69]
    v_pk_add_f32 v[62:63], v[62:63], v[70:71]
    v_perm_b32 v60, v60, v107, s12
    v_perm_b32 v61, v61, v107, s13
    v_perm_b32 v62, v62, v107, s14
    v_perm_b32 v63, v63, v107, s15
    s_cmp_eq_u32 s79, 1
    s_cbranch_scc1 L_tdry1
    buffer_store_dwordx4 v[60:63], v91, s[44:47], s48 offen sc1
    s_waitcnt vmcnt(1)
    s_branch L_tchk
L_tpoll:
    buffer_load_dwordx4 v[40:43], v94, s[44:47], s66 offen sc1
L_yfd:
L_tdry1:
    s_waitcnt vmcnt(0)
L_tchk:
    v_cmp_ne_u32 vcc, s78, v43
    s_cmp_eq_u32 s79, 1
    s_cbranch_scc1 L_tdone
    s_and_b64 exec, exec, vcc
    s_cbranch_execz L_tdone
    s_sub_u32 s70, s70, 1
    s_cmp_lg_u32 s70, 0
    s_cbranch_scc1 L_tpoll
L_tdone:
    s_mov_b64 exec, -1
    v_max_f32_dpp v7, v42, v42 quad_perm:[1,0,3,2] row_mask:0xf bank_mask:0xf
    v_lshlrev_b32 v76, 16, v40
    v_and_b32 v77, 0xffff0000, v40
    v_max_f32_dpp v7, v7, v7 quad_perm:[2,3,0,1] row_mask:0xf bank_mask:0xf
    v_lshlrev_b32 v78, 16, v41
    v_sub_f32 v6, v42, v7
    v_exp_f32 v6, v6
    v_and_b32 v79, 0xffff0000, v41
    s_nop 0
    v_add_f32_dpp v7, v6, v6 quad_perm:[1,0,3,2] row_mask:0xf bank_mask:0xf
    v_pk_mul_f32 v[76:77], v[76:77], v[6:7] op_sel_hi:[1,0]
    v_pk_mul_f32 v[78:79], v[78:79], v[6:7] op_sel_hi:[1,0]
    v_add_f32_dpp v7, v7, v7 quad_perm:[2,3,0,1] row_mask:0xf bank_mask:0xf
    v_add_f32_dpp v76, v76, v76 quad_perm:[1,0,3,2] row_mask:0xf bank_mask:0xf
    v_add_f32_dpp v77, v77, v77 quad_perm:[1,0,3,2] row_mask:0xf bank_mask:0xf
    v_add_f32_dpp v78, v78, v78 quad_perm:[1,0,3,2] row_mask:0xf bank_mask:0xf
    v_add_f32_dpp v79, v79, v79 quad_perm:[1,0,3,2] row_mask:0xf bank_mask:0xf
    v_rcp_f32 v8, v7
    v_add_f32_dpp v76, v76, v76 quad_perm:[2,3,0,1] row_mask:0xf bank_mask:0xf
    v_add_f32_dpp v77, v77, v77 quad_perm:[2,3,0,1] row_mask:0xf bank_mask:0xf
    v_add_f32_dpp v78, v78, v78 quad_perm:[2,3,0,1] row_mask:0xf bank_mask:0xf
    v_add_f32_dpp v79, v79, v79 quad_perm:[2,3,0,1] row_mask:0xf bank_mask:0xf
    v_pk_mul_f32 v[76:77], v[76:77], v[8:9] op_sel_hi:[1,0]
    v_pk_mul_f32 v[78:79], v[78:79], v[8:9] op_sel_hi:[1,0]
    v_cvt_pk_bf16_f32 v76, v76, v76
    v_cvt_pk_bf16_f32 v77, v77, v77
    v_cvt_pk_bf16_f32 v78, v78, v78
    v_cvt_pk_bf16_f32 v79, v79, v79
    v_and_b32 v96, v76, v36
    v_and_b32 v97, v76, v37
    v_and_b32_dpp v98, v76, v38 row_shr:4 row_mask:0xf bank_mask:0xf bound_ctrl:1
    v_and_b32_dpp v99, v76, v39 row_shr:4 row_mask:0xf bank_mask:0xf bound_ctrl:1
    v_and_b32 v100, v77, v36
    v_and_b32 v101, v77, v37
    v_and_b32_dpp v102, v77, v38 row_shr:4 row_mask:0xf bank_mask:0xf bound_ctrl:1
    v_and_b32_dpp v103, v77, v39 row_shr:4 row_mask:0xf bank_mask:0xf bound_ctrl:1
    v_mfma_f32_16x16x32_bf16 v[84:87], v[96:99], v[112:115], 0
    v_and_b32 v96, v78, v36
    v_and_b32 v97, v78, v37
    v_and_b32_dpp v98, v78, v38 row_shr:4 row_mask:0xf bank_mask:0xf bound_ctrl:1
    v_and_b32_dpp v99, v78, v39 row_shr:4 row_mask:0xf bank_mask:0xf bound_ctrl:1
    v_mfma_f32_16x16x32_bf16 v[84:87], v[100:103], v[116:119], v[84:87]
    v_and_b32 v100, v79, v36
    v_and_b32 v101, v79, v37
    v_and_b32_dpp v102, v79, v38 row_shr:4 row_mask:0xf bank_mask:0xf bound_ctrl:1
    v_and_b32_dpp v103, v79, v39 row_shr:4 row_mask:0xf bank_mask:0xf bound_ctrl:1
    v_mfma_f32_16x16x32_bf16 v[84:87], v[96:99], v[120:123], v[84:87]
    v_and_b32_dpp v96, v76, v36 row_shl:4 row_mask:0xf bank_mask:0xf bound_ctrl:1
    v_and_b32_dpp v97, v76, v37 row_shl:4 row_mask:0xf bank_mask:0xf bound_ctrl:1
    v_and_b32 v98, v76, v38
    v_and_b32 v99, v76, v39
    v_mfma_f32_16x16x32_bf16 v[84:87], v[100:103], v[124:127], v[84:87]
    v_and_b32_dpp v100, v77, v36 row_shl:4 row_mask:0xf bank_mask:0xf bound_ctrl:1
    v_and_b32_dpp v101, v77, v37 row_shl:4 row_mask:0xf bank_mask:0xf bound_ctrl:1
    v_and_b32 v102, v77, v38
    v_and_b32 v103, v77, v39
    v_mfma_f32_16x16x32_bf16 v[84:87], v[96:99], v[128:131], v[84:87]
    v_and_b32_dpp v96, v78, v36 row_shl:4 row_mask:0xf bank_mask:0xf bound_ctrl:1
    v_and_b32_dpp v97, v78, v37 row_shl:4 row_mask:0xf bank_mask:0xf bound_ctrl:1
    v_and_b32 v98, v78, v38
    v_and_b32 v99, v78, v39
    v_mfma_f32_16x16x32_bf16 v[84:87], v[100:103], v[132:135], v[84:87]
    v_and_b32_dpp v100, v79, v36 row_shl:4 row_mask:0xf bank_mask:0xf bound_ctrl:1
    v_and_b32_dpp v101, v79, v37 row_shl:4 row_mask:0xf bank_mask:0xf bound_ctrl:1
    v_and_b32 v102, v79, v38
    v_and_b32 v103, v79, v39
    v_mfma_f32_16x16x32_bf16 v[84:87], v[96:99], v[136:139], v[84:87]
    s_nop 0
    v_mfma_f32_16x16x32_bf16 v[84:87], v[100:103], v[140:143], v[84:87]
    s_nop 5
    s_cmp_eq_u32 s79, 1
    s_cbranch_scc1 L_md_93
    ds_write_b128 v105, v[84:87] offset:10368
    v_mov_b32 v5, 1
    s_mov_b64 exec, 1
    ds_add_rtn_u32 v5, v111, v5 offset:8996
    s_mov_b64 exec, -1
L_md_93:
    ds_read_b128 v[60:63], v104 offset:10368
    ds_read_b128 v[64:67], v104 offset:11392
    ds_read_b128 v[68:71], v104 offset:12416
    ds_read_b128 v[72:75], v104 offset:13440
    s_cmp_eq_u32 s79, 1
    s_cbranch_scc1 L_dry_94
    s_waitcnt lgkmcnt(4)
    v_readfirstlane_b32 s64, v5
    s_nop 0
    s_cmp_lg_u32 s64, 3
    s_cbranch_scc1 L_yd
L_dry_94:
    s_waitcnt lgkmcnt(2)
    v_pk_add_f32 v[60:61], v[60:61], v[64:65]
    v_pk_add_f32 v[62:63], v[62:63], v[66:67]
    s_waitcnt lgkmcnt(0)
    v_pk_add_f32 v[68:69], v[68:69], v[72:73]
    v_pk_add_f32 v[70:71], v[70:71], v[74:75]
    v_pk_add_f32 v[60:61], v[60:61], v[68:69]
    v_pk_add_f32 v[62:63], v[62:63], v[70:71]
    v_perm_b32 v60, v60, v107, s12
    v_perm_b32 v61, v61, v107, s13
    v_perm_b32 v62, v62, v107, s14
    v_perm_b32 v63, v63, v107, s15
    s_cmp_eq_u32 s79, 1
    s_cbranch_scc1 L_tdry_ret
    buffer_store_dwordx4 v[60:63], v106, s[44:47], s68 offen sc1
L_yd:
L_aux_exit:
    s_endpgm
L_ffn:
L_qdry:
    s_mul_i32 s66, s60, 576
    s_lshr_b32 s61, s59, 2
    s_mul_i32 s61, s61, 72
    s_add_u32 s66, s66, s61
    v_mov_b32 v76, 0x40000000
    v_mul_u32_u24 v88, 36864, v2
    v_add_u32 v88, v88, v3
    v_cmp_gt_u32 vcc, 9, v1
    s_mul_i32 s67, s3, 1327104
    s_lshl1_add_u32 s67, s66, s67
    v_cndmask_b32 v88, v76, v88, vcc
    v_add_u32 v89, 9216, v88
    v_add_u32 v90, 18432, v88
    v_add_u32 v91, 27648, v88
    s_cmp_eq_u32 s79, 1
    s_cbranch_scc1 L_dry_95
    buffer_load_dwordx4 v[40:43], v88, s[4:7], s67 offen nt
    buffer_load_dwordx4 v[44:47], v88, s[8:11], s67 offen nt
    buffer_load_dwordx4 v[48:51], v89, s[4:7], s67 offen nt
    buffer_load_dwordx4 v[52:55], v89, s[8:11], s67 offen nt
    buffer_load_dwordx4 v[56:59], v90, s[4:7], s67 offen nt
    buffer_load_dwordx4 v[60:63], v90, s[8:11], s67 offen nt
L_dry_95:
    v_lshrrev_b32 v5, 3, v1
    v_lshl_add_u32 v5, v2, 1, v5
    s_mul_i32 s61, s3, 576
    v_lshl_add_u32 v14, v5, 4, s61
    v_lshl_add_u32 v15, v5, 3, s61
    s_cmp_eq_u32 s79, 1
    s_cbranch_scc1 L_dry_96
    s_barrier
L_dry_96:
    ds_read_b128 v[184:187], v14 offset:0
    ds_read_b128 v[188:191], v14 offset:128
    ds_read_b128 v[192:195], v14 offset:256
    ds_read_b128 v[196:199], v14 offset:384
    ds_read_b64 v[200:201], v15 offset:512
    ds_read_b128 v[202:205], v14 offset:2304
    ds_read_b128 v[206:209], v14 offset:2432
    ds_read_b128 v[210:213], v14 offset:2560
    ds_read_b128 v[214:217], v14 offset:2688
    ds_read_b64 v[218:219], v15 offset:2816
    v_and_b32 v14, 0xff, v92
    v_lshrrev_b32 v5, 3, v1
    s_lshl_b32 s61, s3, 10
    v_lshl_add_u32 v14, v5, 9, v14
    v_add_u32 v14, s61, v14
    v_lshlrev_b32 v21, 3, v0
    s_waitcnt lgkmcnt(0)
    v_and_b32 v80, v184, v36
    v_and_b32 v81, v184, v37
    v_and_b32 v82, v184, v38
    v_and_b32 v83, v184, v39
    s_waitcnt vmcnt(23)
    v_and_b32 v84, v202, v36
    v_and_b32 v85, v202, v37
    v_and_b32 v86, v202, v38
    v_and_b32 v87, v202, v39
    s_nop 0
    v_mfma_f32_16x16x32_bf16 v[104:107], v[80:83], v[112:115], 0
    v_mfma_f32_16x16x32_bf16 v[108:111], v[84:87], v[112:115], 0
    v_and_b32 v80, v185, v36
    v_and_b32 v81, v185, v37
    v_and_b32 v82, v185, v38
    v_and_b32 v83, v185, v39
    s_waitcnt vmcnt(22)
    v_and_b32 v84, v203, v36
    v_and_b32 v85, v203, v37
    v_and_b32 v86, v203, v38
    v_and_b32 v87, v203, v39
    s_nop 0
    v_mfma_f32_16x16x32_bf16 v[104:107], v[80:83], v[116:119], v[104:107]
    v_mfma_f32_16x16x32_bf16 v[108:111], v[84:87], v[116:119], v[108:111]
    v_and_b32 v80, v186, v36
    v_and_b32 v81, v186, v37
    v_and_b32 v82, v186, v38
    v_and_b32 v83, v186, v39
    s_waitcnt vmcnt(21)
    v_and_b32 v84, v204, v36
    v_and_b32 v85, v204, v37
    v_and_b32 v86, v204, v38
    v_and_b32 v87, v204, v39
    s_nop 0
    v_mfma_f32_16x16x32_bf16 v[104:107], v[80:83], v[120:123], v[104:107]
    v_mfma_f32_16x16x32_bf16 v[108:111], v[84:87], v[120:123], v[108:111]
    v_and_b32 v80, v187, v36
    v_and_b32 v81, v187, v37
    v_and_b32 v82, v187, v38
    v_and_b32 v83, v187, v39
    s_waitcnt vmcnt(20)
    v_and_b32 v84, v205, v36
    v_and_b32 v85, v205, v37
    v_and_b32 v86, v205, v38
    v_and_b32 v87, v205, v39
    s_nop 0
    v_mfma_f32_16x16x32_bf16 v[104:107], v[80:83], v[124:127], v[104:107]
    v_mfma_f32_16x16x32_bf16 v[108:111], v[84:87], v[124:127], v[108:111]
    v_and_b32 v80, v188, v36
    v_and_b32 v81, v188, v37
    v_and_b32 v82, v188, v38
    v_and_b32 v83, v188, v39
    s_waitcnt vmcnt(19)
    v_and_b32 v84, v206, v36
    v_and_b32 v85, v206, v37
    v_and_b32 v86, v206, v38
    v_and_b32 v87, v206, v39
    s_nop 0
    v_mfma_f32_16x16x32_bf16 v[104:107], v[80:83], v[128:131], v[104:107]
    v_mfma_f32_16x16x32_bf16 v[108:111], v[84:87], v[128:131], v[108:111]
    v_and_b32 v80, v189, v36
    v_and_b32 v81, v189, v37
    v_and_b32 v82, v189, v38
    v_and_b32 v83, v189, v39
    s_waitcnt vmcnt(18)
    v_and_b32 v84, v207, v36
    v_and_b32 v85, v207, v37
    v_and_b32 v86, v207, v38
    v_and_b32 v87, v207, v39
    s_nop 0
    v_mfma_f32_16x16x32_bf16 v[104:107], v[80:83], v[132:135], v[104:107]
    v_mfma_f32_16x16x32_bf16 v[108:111], v[84:87], v[132:135], v[108:111]
    v_and_b32 v80, v190, v36
    v_and_b32 v81, v190, v37
    v_and_b32 v82, v190, v38
    v_and_b32 v83, v190, v39
    s_waitcnt vmcnt(17)
    v_and_b32 v84, v208, v36
    v_and_b32 v85, v208, v37
    v_and_b32 v86, v208, v38
    v_and_b32 v87, v208, v39
    s_nop 0
    v_mfma_f32_16x16x32_bf16 v[104:107], v[80:83], v[136:139], v[104:107]
    v_mfma_f32_16x16x32_bf16 v[108:111], v[84:87], v[136:139], v[108:111]
    v_and_b32 v80, v191, v36
    v_and_b32 v81, v191, v37
    v_and_b32 v82, v191, v38
    v_and_b32 v83, v191, v39
    s_waitcnt vmcnt(16)
    v_and_b32 v84, v209, v36
    v_and_b32 v85, v209, v37
    v_and_b32 v86, v209, v38
    v_and_b32 v87, v209, v39
    s_nop 0
    v_mfma_f32_16x16x32_bf16 v[104:107], v[80:83], v[140:143], v[104:107]
    v_mfma_f32_16x16x32_bf16 v[108:111], v[84:87], v[140:143], v[108:111]
    v_and_b32 v80, v192, v36
    v_and_b32 v81, v192, v37
    v_and_b32 v82, v192, v38
    v_and_b32 v83, v192, v39
    s_waitcnt vmcnt(15)
    v_and_b32 v84, v210, v36
    v_and_b32 v85, v210, v37
    v_and_b32 v86, v210, v38
    v_and_b32 v87, v210, v39
    s_nop 0
    v_mfma_f32_16x16x32_bf16 v[104:107], v[80:83], v[144:147], v[104:107]
    v_mfma_f32_16x16x32_bf16 v[108:111], v[84:87], v[144:147], v[108:111]
    v_and_b32 v80, v193, v36
    v_and_b32 v81, v193, v37
    v_and_b32 v82, v193, v38
    v_and_b32 v83, v193, v39
    s_waitcnt vmcnt(14)
    v_and_b32 v84, v211, v36
    v_and_b32 v85, v211, v37
    v_and_b32 v86, v211, v38
    v_and_b32 v87, v211, v39
    s_nop 0
    v_mfma_f32_16x16x32_bf16 v[104:107], v[80:83], v[148:151], v[104:107]
    v_mfma_f32_16x16x32_bf16 v[108:111], v[84:87], v[148:151], v[108:111]
    v_and_b32 v80, v194, v36
    v_and_b32 v81, v194, v37
    v_and_b32 v82, v194, v38
    v_and_b32 v83, v194, v39
    s_waitcnt vmcnt(13)
    v_and_b32 v84, v212, v36
    v_and_b32 v85, v212, v37
    v_and_b32 v86, v212, v38
    v_and_b32 v87, v212, v39
    s_nop 0
    v_mfma_f32_16x16x32_bf16 v[104:107], v[80:83], v[152:155], v[104:107]
    v_mfma_f32_16x16x32_bf16 v[108:111], v[84:87], v[152:155], v[108:111]
    v_and_b32 v80, v195, v36
    v_and_b32 v81, v195, v37
    v_and_b32 v82, v195, v38
    v_and_b32 v83, v195, v39
    s_waitcnt vmcnt(12)
    v_and_b32 v84, v213, v36
    v_and_b32 v85, v213, v37
    v_and_b32 v86, v213, v38
    v_and_b32 v87, v213, v39
    s_nop 0
    v_mfma_f32_16x16x32_bf16 v[104:107], v[80:83], v[156:159], v[104:107]
    v_mfma_f32_16x16x32_bf16 v[108:111], v[84:87], v[156:159], v[108:111]
    v_and_b32 v80, v196, v36
    v_and_b32 v81, v196, v37
    v_and_b32 v82, v196, v38
    v_and_b32 v83, v196, v39
    s_waitcnt vmcnt(11)
    v_and_b32 v84, v214, v36
    v_and_b32 v85, v214, v37
    v_and_b32 v86, v214, v38
    v_and_b32 v87, v214, v39
    s_nop 0
    v_mfma_f32_16x16x32_bf16 v[104:107], v[80:83], v[160:163], v[104:107]
    v_mfma_f32_16x16x32_bf16 v[108:111], v[84:87], v[160:163], v[108:111]
    v_and_b32 v80, v197, v36
    v_and_b32 v81, v197, v37
    v_and_b32 v82, v197, v38
    v_and_b32 v83, v197, v39
    s_waitcnt vmcnt(10)
    v_and_b32 v84, v215, v36
    v_and_b32 v85, v215, v37
    v_and_b32 v86, v215, v38
    v_and_b32 v87, v215, v39
    s_nop 0
    v_mfma_f32_16x16x32_bf16 v[104:107], v[80:83], v[164:167], v[104:107]
    v_mfma_f32_16x16x32_bf16 v[108:111], v[84:87], v[164:167], v[108:111]
    v_and_b32 v80, v198, v36
    v_and_b32 v81, v198, v37
    v_and_b32 v82, v198, v38
    v_and_b32 v83, v198, v39
    s_waitcnt vmcnt(9)
    v_and_b32 v84, v216, v36
    v_and_b32 v85, v216, v37
    v_and_b32 v86, v216, v38
    v_and_b32 v87, v216, v39
    s_nop 0
    v_mfma_f32_16x16x32_bf16 v[104:107], v[80:83], v[168:171], v[104:107]
    v_mfma_f32_16x16x32_bf16 v[108:111], v[84:87], v[168:171], v[108:111]
    v_and_b32 v80, v199, v36
    v_and_b32 v81, v199, v37
    v_and_b32 v82, v199, v38
    v_and_b32 v83, v199, v39
    s_waitcnt vmcnt(8)
    v_and_b32 v84, v217, v36
    v_and_b32 v85, v217, v37
    v_and_b32 v86, v217, v38
    v_and_b32 v87, v217, v39
    s_nop 0
    v_mfma_f32_16x16x32_bf16 v[104:107], v[80:83], v[172:175], v[104:107]
    v_mfma_f32_16x16x32_bf16 v[108:111], v[84:87], v[172:175], v[108:111]
    v_and_b32 v80, v200, v36
    v_and_b32 v81, v200, v37
    v_and_b32 v82, v200, v38
    v_and_b32 v83, v200, v39
    s_waitcnt vmcnt(7)
    v_and_b32 v84, v218, v36
    v_and_b32 v85, v218, v37
    v_and_b32 v86, v218, v38
    v_and_b32 v87, v218, v39
    s_nop 0
    v_mfma_f32_16x16x32_bf16 v[104:107], v[80:83], v[176:179], v[104:107]
    v_mfma_f32_16x16x32_bf16 v[108:111], v[84:87], v[176:179], v[108:111]
    v_and_b32 v80, v201, v36
    v_and_b32 v81, v201, v37
    v_and_b32 v82, v201, v38
    v_and_b32 v83, v201, v39
    s_waitcnt vmcnt(6)
    v_and_b32 v84, v219, v36
    v_and_b32 v85, v219, v37
    v_and_b32 v86, v219, v38
    v_and_b32 v87, v219, v39
    s_nop 0
    v_mfma_f32_16x16x32_bf16 v[104:107], v[80:83], v[180:183], v[104:107]
    v_mfma_f32_16x16x32_bf16 v[108:111], v[84:87], v[180:183], v[108:111]
    s_nop 5
    s_cmp_eq_u32 s79, 1
    s_cbranch_scc1 L_dry_97
    s_mov_b32 exec_lo, 0x00ff00ff
    s_mov_b32 exec_hi, 0xff00ff00
    ds_write_b128 v14, v[104:107] offset:10368
    ds_write_b128 v14, v[108:111] offset:10624
    s_mov_b64 exec, -1
    s_waitcnt lgkmcnt(0)
    s_barrier
    s_cmp_lg_u32 s3, 0
    s_cbranch_scc1 L_nopubq
L_dry_97:
    ds_read_b64 v[4:5], v21 offset:10368
    ds_read_b64 v[6:7], v21 offset:10880
    ds_read_b64 v[8:9], v21 offset:11392
    ds_read_b64 v[10:11], v21 offset:11904
    ds_read_b64 v[12:13], v21 offset:12416
    ds_read_b64 v[14:15], v21 offset:12928
    ds_read_b64 v[16:17], v21 offset:13440
    ds_read_b64 v[18:19], v21 offset:13952
    v_lshrrev_b32 v20, 5, v0
    v_lshlrev_b32 v20, 8, v20
    v_add_u32 v20, v20, v21
    s_lshl_b32 s61, s56, 10
    s_lshl_b32 s63, s57, 8
    s_add_u32 s61, s61, s63
    s_add_u32 s61, s61, 593920
    s_waitcnt lgkmcnt(0)
    v_pk_add_f32 v[4:5], v[4:5], v[6:7]
    v_pk_add_f32 v[8:9], v[8:9], v[10:11]
    v_pk_add_f32 v[12:13], v[12:13], v[14:15]
    v_pk_add_f32 v[16:17], v[16:17], v[18:19]
    v_pk_add_f32 v[4:5], v[4:5], v[8:9]
    v_pk_add_f32 v[12:13], v[12:13], v[16:17]
    v_pk_add_f32 v[4:5], v[4:5], v[12:13]
    v_cvt_pk_bf16_f32 v4, v4, v5
    v_mov_b32 v5, s78
    buffer_store_dwordx2 v[4:5], v20, s[44:47], s61 offen sc1
L_nopubq:
    s_waitcnt vmcnt(5)
    buffer_load_dwordx4 v[64:67], v91, s[4:7], s67 offen nt
    s_waitcnt vmcnt(5)
    buffer_load_dwordx4 v[68:71], v91, s[8:11], s67 offen nt
    s_add_u32 s67, s67, 147456
    v_lshrrev_b32 v77, 3, v1
    v_mul_u32_u24 v77, 2304, v77
    v_lshl_add_u32 v77, v2, 4, v77
    s_mul_i32 s61, s3, 576
    v_add_u32 v77, s61, v77
    ds_read_b128 v[72:75], v77 offset:0
    v_mov_b32 v24, 0
    v_mov_b32 v25, 0
    v_mov_b32 v26, 0
    v_mov_b32 v27, 0
    v_mov_b32 v28, 0
    v_mov_b32 v29, 0
    v_mov_b32 v30, 0
    v_mov_b32 v31, 0
    s_mov_b32 s68, 0
L_ffn1:
    s_waitcnt lgkmcnt(0)
    ds_read_b128 v[104:107], v77 offset:64
    v_and_b32 v96, v72, v36
    v_and_b32 v97, v72, v37
    v_and_b32 v98, v72, v38
    v_and_b32 v99, v72, v39
    s_waitcnt vmcnt(7)
    s_nop 0
    v_mfma_f32_16x16x32_bf16 v[24:27], v[96:99], v[40:43], v[24:27]
    s_waitcnt vmcnt(5)
    buffer_load_dwordx4 v[40:43], v88, s[4:7], s67 offen nt
    s_waitcnt vmcnt(7)
    v_mfma_f32_16x16x32_bf16 v[28:31], v[96:99], v[44:47], v[28:31]
    s_waitcnt vmcnt(5)
    buffer_load_dwordx4 v[44:47], v88, s[8:11], s67 offen nt
    v_and_b32 v100, v73, v36
    v_and_b32 v101, v73, v37
    v_and_b32 v102, v73, v38
    v_and_b32 v103, v73, v39
    s_waitcnt vmcnt(7)
    s_nop 0
    v_mfma_f32_16x16x32_bf16 v[24:27], v[100:103], v[48:51], v[24:27]
    s_waitcnt vmcnt(5)
    buffer_load_dwordx4 v[48:51], v89, s[4:7], s67 offen nt
    s_waitcnt vmcnt(7)
    v_mfma_f32_16x16x32_bf16 v[28:31], v[100:103], v[52:55], v[28:31]
    s_waitcnt vmcnt(5)
    buffer_load_dwordx4 v[52:55], v89, s[8:11], s67 offen nt
    v_and_b32 v96, v74, v36
    v_and_b32 v97, v74, v37
    v_and_b32 v98, v74, v38
    v_and_b32 v99, v74, v39
    s_waitcnt vmcnt(7)
    s_nop 0
    v_mfma_f32_16x16x32_bf16 v[24:27], v[96:99], v[56:59], v[24:27]
    s_waitcnt vmcnt(5)
    buffer_load_dwordx4 v[56:59], v90, s[4:7], s67 offen nt
    s_waitcnt vmcnt(7)
    v_mfma_f32_16x16x32_bf16 v[28:31], v[96:99], v[60:63], v[28:31]
    s_waitcnt vmcnt(5)
    buffer_load_dwordx4 v[60:63], v90, s[8:11], s67 offen nt
    v_and_b32 v100, v75, v36
    v_and_b32 v101, v75, v37
    v_and_b32 v102, v75, v38
    v_and_b32 v103, v75, v39
    s_waitcnt vmcnt(7)
    s_nop 0
    v_mfma_f32_16x16x32_bf16 v[24:27], v[100:103], v[64:67], v[24:27]
    s_waitcnt vmcnt(5)
    buffer_load_dwordx4 v[64:67], v91, s[4:7], s67 offen nt
    s_waitcnt vmcnt(7)
    v_mfma_f32_16x16x32_bf16 v[28:31], v[100:103], v[68:71], v[28:31]
    s_waitcnt vmcnt(5)
    buffer_load_dwordx4 v[68:71], v91, s[8:11], s67 offen nt
    s_add_u32 s67, s67, 147456
    s_waitcnt lgkmcnt(0)
    ds_read_b128 v[72:75], v77 offset:128
    v_and_b32 v96, v104, v36
    v_and_b32 v97, v104, v37
    v_and_b32 v98, v104, v38
    v_and_b32 v99, v104, v39
    s_waitcnt vmcnt(7)
    s_nop 0
    v_mfma_f32_16x16x32_bf16 v[24:27], v[96:99], v[40:43], v[24:27]
    s_waitcnt vmcnt(5)
    buffer_load_dwordx4 v[40:43], v88, s[4:7], s67 offen nt
    s_waitcnt vmcnt(7)
    v_mfma_f32_16x16x32_bf16 v[28:31], v[96:99], v[44:47], v[28:31]
    s_waitcnt vmcnt(5)
    buffer_load_dwordx4 v[44:47], v88, s[8:11], s67 offen nt
    v_and_b32 v100, v105, v36
    v_and_b32 v101, v105, v37
    v_and_b32 v102, v105, v38
    v_and_b32 v103, v105, v39
    s_waitcnt vmcnt(7)
    s_nop 0
    v_mfma_f32_16x16x32_bf16 v[24:27], v[100:103], v[48:51], v[24:27]
    s_waitcnt vmcnt(5)
    buffer_load_dwordx4 v[48:51], v89, s[4:7], s67 offen nt
    s_waitcnt vmcnt(7)
    v_mfma_f32_16x16x32_bf16 v[28:31], v[100:103], v[52:55], v[28:31]
    s_waitcnt vmcnt(5)
    buffer_load_dwordx4 v[52:55], v89, s[8:11], s67 offen nt
    v_and_b32 v96, v106, v36
    v_and_b32 v97, v106, v37
    v_and_b32 v98, v106, v38
    v_and_b32 v99, v106, v39
    s_waitcnt vmcnt(7)
    s_nop 0
    v_mfma_f32_16x16x32_bf16 v[24:27], v[96:99], v[56:59], v[24:27]
    s_waitcnt vmcnt(5)
    buffer_load_dwordx4 v[56:59], v90, s[4:7], s67 offen nt
    s_waitcnt vmcnt(7)
    v_mfma_f32_16x16x32_bf16 v[28:31], v[96:99], v[60:63], v[28:31]
    s_waitcnt vmcnt(5)
    buffer_load_dwordx4 v[60:63], v90, s[8:11], s67 offen nt
    v_and_b32 v100, v107, v36
    v_and_b32 v101, v107, v37
    v_and_b32 v102, v107, v38
    v_and_b32 v103, v107, v39
    s_waitcnt vmcnt(7)
    s_nop 0
    v_mfma_f32_16x16x32_bf16 v[24:27], v[100:103], v[64:67], v[24:27]
    s_waitcnt vmcnt(5)
    buffer_load_dwordx4 v[64:67], v91, s[4:7], s67 offen nt
    s_waitcnt vmcnt(7)
    v_mfma_f32_16x16x32_bf16 v[28:31], v[100:103], v[68:71], v[28:31]
    s_waitcnt vmcnt(5)
    buffer_load_dwordx4 v[68:71], v91, s[8:11], s67 offen nt
    s_add_u32 s67, s67, 147456
    v_add_u32 v77, 128, v77
    s_add_u32 s68, s68, 1
    s_cmp_lt_u32 s68, 4
    s_cbranch_scc1 L_ffn1
    s_barrier
    s_waitcnt lgkmcnt(0)
    v_and_b32 v96, v72, v36
    v_and_b32 v97, v72, v37
    v_and_b32 v98, v72, v38
    v_and_b32 v99, v72, v39
    s_waitcnt vmcnt(7)
    s_nop 0
    v_mfma_f32_16x16x32_bf16 v[24:27], v[96:99], v[40:43], v[24:27]
    s_waitcnt vmcnt(6)
    v_mfma_f32_16x16x32_bf16 v[28:31], v[96:99], v[44:47], v[28:31]
    v_and_b32 v100, v73, v36
    v_and_b32 v101, v73, v37
    v_and_b32 v102, v73, v38
    v_and_b32 v103, v73, v39
    s_waitcnt vmcnt(5)
    s_nop 0
    v_mfma_f32_16x16x32_bf16 v[24:27], v[100:103], v[48:51], v[24:27]
    s_waitcnt vmcnt(4)
    v_mfma_f32_16x16x32_bf16 v[28:31], v[100:103], v[52:55], v[28:31]
    v_and_b32 v96, v74, v36
    v_and_b32 v97, v74, v37
    v_and_b32 v98, v74, v38
    v_and_b32 v99, v74, v39
    s_waitcnt vmcnt(3)
    s_nop 0
    v_mfma_f32_16x16x32_bf16 v[24:27], v[96:99], v[56:59], v[24:27]
    s_waitcnt vmcnt(2)
    v_mfma_f32_16x16x32_bf16 v[28:31], v[96:99], v[60:63], v[28:31]
    v_and_b32 v100, v75, v36
    v_and_b32 v101, v75, v37
    v_and_b32 v102, v75, v38
    v_and_b32 v103, v75, v39
    s_waitcnt vmcnt(1)
    s_nop 0
    v_mfma_f32_16x16x32_bf16 v[24:27], v[100:103], v[64:67], v[24:27]
    s_waitcnt vmcnt(0)
    v_mfma_f32_16x16x32_bf16 v[28:31], v[100:103], v[68:71], v[28:31]
    s_lshl_b32 s61, s3, 11
    v_lshlrev_b32 v82, 4, v0
    v_add_u32 v83, s61, v82
    s_nop 4
    ds_write_b128 v83, v[24:27] offset:10368
    ds_write_b128 v83, v[28:31] offset:11392
    s_cmp_lg_u32 s3, 0
    s_cbranch_scc1 L_qd_98
    s_lshl1_add_u32 s61, s56, s57
    s_lshl_b32 s61, s61, 9
    s_add_u32 s61, s61, 593920
    v_lshlrev_b32 v32, 3, v0
    v_lshlrev_b32 v33, 2, v0
    s_mov_b32 s70, 2097152
L_qp_99:
    buffer_load_dwordx2 v[34:35], v32, s[44:47], s61 offen sc1
    s_waitcnt vmcnt(0)
    v_cmp_ne_u32 vcc, s78, v35
    s_nop 4
    s_cbranch_vccz L_qo_100
    s_sub_u32 s70, s70, 1
    s_cmp_lg_u32 s70, 0
    s_cbranch_scc1 L_qp_99
L_qo_100:
    ds_write_b32 v33, v34 offset:6656
L_qd_98:
    s_waitcnt lgkmcnt(0)
    s_barrier
    s_cmp_lg_u32 s3, 1
    s_cbranch_scc1 L_ffn_ret
    ds_read_b128 v[40:43], v82 offset:10368
    ds_read_b128 v[44:47], v82 offset:11392
    ds_read_b128 v[48:51], v82 offset:12416
    ds_read_b128 v[52:55], v82 offset:13440
    ds_read_b128 v[56:59], v82 offset:14464
    ds_read_b128 v[60:63], v82 offset:15488
    ds_read_b128 v[64:67], v82 offset:16512
    ds_read_b128 v[68:71], v82 offset:17536
    v_lshrrev_b32 v77, 1, v2
    v_mul_u32_u24 v77, 288, v77
    v_add_u32 v77, v77, v92
    v_cmp_gt_u32 vcc, 9, v1
    s_lshl_b32 s61, s60, 3
    s_lshr_b32 s67, s59, 2
    s_add_u32 s61, s61, s67
    v_cndmask_b32 v77, v76, v77, vcc
    s_mul_i32 s61, s61, 576
    s_add_u32 s67, s61, 524288
    s_waitcnt lgkmcnt(0)
    v_pk_add_f32 v[40:41], v[40:41], v[48:49]
    v_pk_add_f32 v[42:43], v[42:43], v[50:51]
    v_pk_add_f32 v[44:45], v[44:45], v[52:53]
    v_pk_add_f32 v[46:47], v[46:47], v[54:55]
    v_pk_add_f32 v[40:41], v[40:41], v[56:57]
    v_pk_add_f32 v[42:43], v[42:43], v[58:59]
    v_pk_add_f32 v[44:45], v[44:45], v[60:61]
    v_pk_add_f32 v[46:47], v[46:47], v[62:63]
    v_pk_add_f32 v[40:41], v[40:41], v[64:65]
    v_pk_add_f32 v[42:43], v[42:43], v[66:67]
    v_pk_add_f32 v[44:45], v[44:45], v[68:69]
    v_pk_add_f32 v[46:47], v[46:47], v[70:71]
    v_cvt_pk_bf16_f32 v48, v40, v41
    v_lshlrev_b32 v40, 16, v48
    v_and_b32 v41, 0xffff0000, v48
    v_cvt_pk_bf16_f32 v49, v42, v43
    v_lshlrev_b32 v42, 16, v49
    v_and_b32 v43, 0xffff0000, v49
    v_cvt_pk_bf16_f32 v50, v44, v45
    v_lshlrev_b32 v44, 16, v50
    v_and_b32 v45, 0xffff0000, v50
    v_cvt_pk_bf16_f32 v51, v46, v47
    v_lshlrev_b32 v46, 16, v51
    v_and_b32 v47, 0xffff0000, v51
    v_mul_f32 v48, 0xbfb8aa3b, v40
    v_mul_f32 v49, 0xbfb8aa3b, v41
    v_mul_f32 v50, 0xbfb8aa3b, v42
    v_mul_f32 v51, 0xbfb8aa3b, v43
    v_exp_f32 v48, v48
    v_exp_f32 v49, v49
    v_exp_f32 v50, v50
    v_exp_f32 v51, v51
    s_nop 0
    v_add_f32 v48, 1.0, v48
    v_add_f32 v49, 1.0, v49
    v_add_f32 v50, 1.0, v50
    v_add_f32 v51, 1.0, v51
    v_rcp_f32 v48, v48
    v_rcp_f32 v49, v49
    v_rcp_f32 v50, v50
    v_rcp_f32 v51, v51
    s_nop 0
    v_mul_f32 v40, v40, v48
    v_mul_f32 v41, v41, v49
    v_mul_f32 v42, v42, v50
    v_mul_f32 v43, v43, v51
    v_cvt_pk_bf16_f32 v48, v40, v41
    v_lshlrev_b32 v40, 16, v48
    v_and_b32 v41, 0xffff0000, v48
    v_cvt_pk_bf16_f32 v49, v42, v43
    v_lshlrev_b32 v42, 16, v49
    v_and_b32 v43, 0xffff0000, v49
    v_mul_f32 v40, v40, v44
    v_mul_f32 v41, v41, v45
    v_mul_f32 v42, v42, v46
    v_mul_f32 v43, v43, v47
    v_cvt_pk_bf16_f32 v44, v40, v41
    v_cvt_pk_bf16_f32 v45, v42, v43
    v_mov_b32 v46, s78
    v_mov_b32 v47, s78
    buffer_store_dwordx4 v[44:47], v77, s[44:47], s67 offen sc1
    s_branch L_ffn_ret
L_end:
    s_endpgm
.section .rodata,"a"
.p2align 6
.amdhsa_kernel recurrent_scan__mha_block_cached__swiglu_ffn__decode_kernel
  .amdhsa_next_free_vgpr 256
  .amdhsa_next_free_sgpr 102
  .amdhsa_accum_offset 256
  .amdhsa_group_segment_fixed_size 0
  .amdhsa_kernarg_size 96
  .amdhsa_user_sgpr_count 2
  .amdhsa_user_sgpr_kernarg_segment_ptr 1
  .amdhsa_system_sgpr_workgroup_id_x 1
  .amdhsa_float_denorm_mode_32 3
.end_amdhsa_kernel
```
